```python
import torch

def _softmax(x, axis=-1):
    return torch.softmax(x, dim=axis)

def _gelu(x):
    return torch.nn.functional.gelu(x, approximate='tanh')

def _silu(x):
    return torch.nn.functional.silu(x)

def _sigmoid(x):
    return torch.sigmoid(x)

def _layernorm(x, axis=-1, eps=1e-05):
    m = x.mean(dim=axis, keepdim=True)
    v = x.var(dim=axis, keepdim=True, unbiased=False)
    return (x - m) / torch.sqrt(v + eps)

def _scatter_add(tgt, idx, src, axis=0):
    return tgt.clone().index_add_(axis, idx, src)

def _segment_sum(src, seg, n):
    out = torch.zeros((n,) + src.shape[1:], dtype=src.dtype)
    return out.index_add_(0, seg, src)

def _pad(x, pw):
    flat = tuple((v for pair in reversed(pw) for v in pair))
    return torch.nn.functional.pad(x, flat)
kernel_name = 'parallel_sum__memory_aug_recurrent_mem_tr__swiglu_ffn__prompt'

def setup_inputs():

    _w = lambda a: (lambda t: t.to(torch.bfloat16) if t.is_floating_point() else t)(torch.as_tensor(a))

    def _A_setup():
        B, S, Dm = (1, 2048, 512)
        H, Dh = (32, 128)
        M, seg = (8, 32)
        seg = min(seg, S)
        S = S // seg * seg
        return {'x': _w((lambda *s: torch.randn(*s, dtype=torch.bfloat16) * 0.05)(B, S, Dm)), 'mem0': _w((lambda *s: torch.randn(*s, dtype=torch.bfloat16) * 1.6)(B, M, Dm)), 'Wq': _w((lambda *s: torch.randn(*s, dtype=torch.bfloat16) * 0.8)(Dm, H, Dh) * Dm ** (-0.5)), 'Wk': _w((lambda *s: torch.randn(*s, dtype=torch.bfloat16) * 0.8)(Dm, H, Dh) * Dm ** (-0.5)), 'Wv': _w((lambda *s: torch.randn(*s, dtype=torch.bfloat16) * 1.6)(Dm, H, Dh) * Dm ** (-0.5)), 'Wo': _w((lambda *s: torch.randn(*s, dtype=torch.bfloat16) * 1.6)(H, Dh, Dm) * (H * Dh) ** (-0.5)), 'seg_len': seg}
    _A_in = _A_setup()

    def _B_setup():
        B, S, D, F = (1, 2048, 512, 1792)
        return {'x': _w((lambda *s: torch.randn(*s, dtype=torch.bfloat16) * 0.05)(B, S, D)), 'w_gate': _w((lambda *s: torch.randn(*s, dtype=torch.bfloat16) * 0.05)(D, F)), 'w_up': _w((lambda *s: torch.randn(*s, dtype=torch.bfloat16) * 0.05)(D, F)), 'w_down': _w((lambda *s: torch.randn(*s, dtype=torch.bfloat16) * 0.05)(F, D))}
    _B_in = _B_setup()
    return {'A_x': _A_in['x'], 'A_mem0': _A_in['mem0'], 'A_Wq': _A_in['Wq'], 'A_Wk': _A_in['Wk'], 'A_Wv': _A_in['Wv'], 'A_Wo': _A_in['Wo'], 'A_seg_len': _A_in['seg_len'], 'B_x': _B_in['x'], 'B_w_gate': _B_in['w_gate'], 'B_w_up': _B_in['w_up'], 'B_w_down': _B_in['w_down']}

def reference(A_x, A_mem0, A_Wq, A_Wk, A_Wv, A_Wo, A_seg_len, B_x, B_w_gate, B_w_up, B_w_down):

    def _A_ref(x, mem0, Wq, Wk, Wv, Wo, seg_len):
        B, S, Dm = x.shape
        H, Dh = (Wq.shape[1], Wq.shape[2])
        M = mem0.shape[1]
        scale = Dh ** (-0.5)
        n_seg = S // seg_len
        L = M + seg_len
        idx = torch.arange(L)
        mask = (idx[:, None] < M) | (idx[:, None] >= idx[None, :])
        mem = mem0
        outs = []
        for s in range(n_seg):
            xs = x[:, s * seg_len:(s + 1) * seg_len, :].clone()
            h = torch.concatenate([mem, xs], axis=1)
            q = torch.einsum('btd,dhe->bhte', h, Wq)
            k = torch.einsum('btd,dhe->bhte', h, Wk)
            v = torch.einsum('btd,dhe->bhte', h, Wv)
            scores = torch.einsum('bhqe,bhke->bhqk', q, k) * scale
            scores = torch.where(mask[None, None], scores, -1000000000.0)
            p = _softmax(scores, axis=-1)
            o = torch.einsum('bhqk,bhke->bhqe', p, v)
            o = torch.einsum('bhte,hed->btd', o, Wo)
            mem = o[:, :M, :].clone()
            outs.append(o[:, M:, :])
        return torch.concatenate(outs, axis=1)

    def _B_ref(x, w_gate, w_up, w_down):
        g = _silu(x @ w_gate)
        u = x @ w_up
        return g * u @ w_down
    x = A_x
    xn = _layernorm(x, axis=-1)
    return x + _A_ref(xn, A_mem0, A_Wq, A_Wk, A_Wv, A_Wo, A_seg_len) + _B_ref(xn, B_w_gate, B_w_up, B_w_down)
```

```asm
; @launch grid=(256,1,1) block=(256,1,1) lds=163840
.amdgcn_target "amdgcn-amd-amdhsa--gfx950"
.text
.globl parallel_sum__memory_aug_recurrent_mem_tr__swiglu_ffn__prompt_kernel
.p2align 8
.type parallel_sum__memory_aug_recurrent_mem_tr__swiglu_ffn__prompt_kernel,@function
parallel_sum__memory_aug_recurrent_mem_tr__swiglu_ffn__prompt_kernel:
    s_load_dwordx2 s[8:9], s[0:1], 0
    s_load_dwordx2 s[12:13], s[0:1], 8
    s_load_dwordx2 s[16:17], s[0:1], 16
    s_load_dwordx2 s[20:21], s[0:1], 24
    s_load_dwordx2 s[24:25], s[0:1], 32
    s_load_dwordx2 s[28:29], s[0:1], 40
    s_load_dwordx2 s[32:33], s[0:1], 64
    s_load_dwordx2 s[36:37], s[0:1], 72
    s_load_dwordx2 s[40:41], s[0:1], 80
    s_load_dwordx2 s[44:45], s[0:1], 88
    s_load_dwordx2 s[48:49], s[0:1], 96
    s_load_dwordx2 s[52:53], s[0:1], 104
    v_lshrrev_b32 v1, 6, v0
    v_and_b32 v2, 63, v0
    s_getreg_b32 s60, hwreg(HW_REG_XCC_ID)
    v_readfirstlane_b32 s56, v1
    s_and_b32 s60, s60, 7
    s_mov_b32 s10, 2097152
    s_mov_b32 s11, 0x20000
    s_mov_b32 s14, 8192
    s_mov_b32 s15, 0x20000
    s_mov_b32 s18, 4194304
    s_mov_b32 s19, 0x20000
    s_mov_b32 s22, 4194304
    s_mov_b32 s23, 0x20000
    s_mov_b32 s26, 4194304
    s_mov_b32 s27, 0x20000
    s_mov_b32 s30, 4194304
    s_mov_b32 s31, 0x20000
    s_mov_b32 s34, 1835008
    s_mov_b32 s35, 0x20000
    s_mov_b32 s38, 1835008
    s_mov_b32 s39, 0x20000
    s_mov_b32 s42, 1835008
    s_mov_b32 s43, 0x20000
    s_mov_b32 s46, 2097152
    s_mov_b32 s47, 0x20000
    s_mov_b32 s50, 256
    s_mov_b32 s51, 0x20000
    s_mov_b32 s54, 176160768
    s_mov_b32 s55, 0x20000
    s_mov_b32 s58, 0
    s_lshl_b32 s61, s56, 15
    s_add_u32 s61, s61, 0x8000
    v_lshlrev_b32 v0, 4, v2
    v_mov_b32 v3, 0x3ff0
    s_waitcnt lgkmcnt(0)
    s_cmp_lg_u32 s56, 0
    s_cbranch_scc1 .pf2
    s_mov_b64 exec, 1
    s_mov_b32 s3, s60
    s_mov_b32 s4, 8
.tkl3:
    v_mov_b32 v4, 1
    s_lshl_b32 s5, s3, 5
    buffer_atomic_add v4, off, s[48:51], s5 sc0 sc1
    s_waitcnt vmcnt(0)
    v_readfirstlane_b32 s6, v4
    s_nop 0
    s_add_u32 s7, s5, s6
    s_cmp_lt_u32 s6, 32
    s_cbranch_scc1 .tkg4
    s_add_u32 s3, s3, 1
    s_and_b32 s3, s3, 7
    s_sub_u32 s4, s4, 1
    s_cmp_lg_u32 s4, 0
    s_cbranch_scc1 .tkl3
    s_mov_b32 s7, -1
.tkg4:
    v_mov_b32 v4, s7
    ds_write_b32 v3, v4
    s_mov_b64 exec, -1
    s_waitcnt lgkmcnt(0)
    s_branch .tk1
.pf2:
    s_lshr_b32 s3, s2, 3
    s_cmp_eq_u32 s60, 0
    s_cbranch_scc1 .px5
    s_mul_i32 s3, s3, 7
    s_add_u32 s3, s3, s60
    s_mul_i32 s3, s3, 3
    s_add_u32 s3, s3, s56
    s_sub_u32 s3, s3, 4
    s_mul_i32 s3, s3, 7168
    s_add_u32 s4, s3, 4096
    s_branch .tk1
.px5:
    s_and_b32 s4, s3, 3
    s_mul_i32 s4, s4, 3
    s_add_u32 s4, s4, s56
    s_sub_u32 s4, s4, 1
    s_mul_i32 s4, s4, 11264
    s_and_b32 s3, s3, 28
    s_sub_u32 s5, 0x100, s20
    s_bfe_u32 s5, s5, 0x20008
    s_add_u32 s3, s3, s5
    s_lshl_b32 s3, s3, 17
    s_add_u32 s3, s3, s4
    buffer_load_dwordx4 v[124:127], v0, s[28:31], s3 offen offset:0
    buffer_load_dwordx4 v[124:127], v0, s[28:31], s3 offen offset:1024
    buffer_load_dwordx4 v[124:127], v0, s[28:31], s3 offen offset:2048
    buffer_load_dwordx4 v[124:127], v0, s[28:31], s3 offen offset:3072
    s_add_u32 s3, s3, 4096
    buffer_load_dwordx4 v[124:127], v0, s[28:31], s3 offen offset:0
    buffer_load_dwordx4 v[124:127], v0, s[28:31], s3 offen offset:1024
    buffer_load_dwordx4 v[124:127], v0, s[28:31], s3 offen offset:2048
    buffer_load_dwordx4 v[124:127], v0, s[28:31], s3 offen offset:3072
    s_add_u32 s3, s3, 4096
    buffer_load_dwordx4 v[124:127], v0, s[28:31], s3 offen offset:0
    buffer_load_dwordx4 v[124:127], v0, s[28:31], s3 offen offset:1024
    buffer_load_dwordx4 v[124:127], v0, s[28:31], s3 offen offset:2048
.tk1:
    s_barrier
    ds_read_b32 v4, v3
    s_waitcnt lgkmcnt(0)
    v_readfirstlane_b32 s57, v4
    s_nop 0
    s_cmp_eq_u32 s57, -1
    s_cbranch_scc1 .Lend
    s_cmp_lt_u32 s57, 32
    s_cbranch_scc1 .Lrec
    s_sub_u32 s62, s57, 32
    s_lshl_b32 s3, s62, 2
    s_add_u32 s3, s3, s56
    s_lshl_b32 s4, s3, 12
    v_and_b32 v4, 0xf0, v0
    v_and_b32 v5, 0x300, v0
    v_lshl_or_b32 v4, v5, 2, v4
    buffer_load_dwordx4 v[16:19], v4, s[8:11], s4 offen offset:0
    buffer_load_dwordx4 v[20:23], v4, s[8:11], s4 offen offset:256
    buffer_load_dwordx4 v[24:27], v4, s[8:11], s4 offen offset:512
    buffer_load_dwordx4 v[28:31], v4, s[8:11], s4 offen offset:768
    v_bfe_u32 v6, v0, 6, 2
    v_lshlrev_b32 v6, 11, v6
    v_bfe_u32 v7, v0, 4, 2
    v_lshl_or_b32 v6, v7, 8, v6
    v_lshrrev_b32 v7, 4, v5
    v_or_b32 v6, v6, v7
    s_lshr_b32 s5, s3, 3
    s_lshl_b32 s5, s5, 15
    s_and_b32 s6, s3, 1
    s_lshl_b32 s6, s6, 10
    s_add_u32 s5, s5, s6
    s_bfe_u32 s6, s3, 0x20001
    s_lshl_b32 s6, s6, 6
    s_add_u32 s5, s5, s6
    s_cmp_lg_u32 s56, 0
    s_cbranch_scc1 .rf6
    v_mov_b32 v104, 0
    v_mov_b32 v105, 0
    v_lshrrev_b32 v106, 1, v0
    s_lshl_b32 s3, s57, 9
    s_add_u32 s3, s3, 167772160
    buffer_store_dwordx2 v[104:105], v106, s[52:55], s3 offen sc1
    v_mov_b32 v108, -1
    v_mov_b32 v109, -1
    v_mov_b32 v110, -1
    v_mov_b32 v111, -1
    s_lshl_b32 s3, s57, 11
    s_add_u32 s3, s3, 69206016
    buffer_store_dwordx4 v[108:111], v0, s[52:55], s3 offen offset:0 sc1
    buffer_store_dwordx4 v[108:111], v0, s[52:55], s3 offen offset:1024 sc1
.rf6:
    s_mul_i32 s63, s62, 9363
    s_lshr_b32 s63, s63, 16
    s_mul_i32 s3, s63, 7
    s_sub_u32 s64, s62, s3
    s_add_u32 s3, s64, 4
    s_sub_u32 s64, s64, 3
    s_cselect_b32 s64, s3, s64
    v_and_b32 v1, 0xf0, v0
    v_and_b32 v8, 0x300, v0
    v_lshlrev_b32 v8, 1, v8
    v_add3_u32 v1, v1, v8, s61
    v_bfe_u32 v8, v0, 6, 1
    v_lshlrev_b32 v100, 0, v8
    v_bfe_u32 v8, v0, 7, 1
    v_lshl_or_b32 v100, v8, 1, v100
    v_bfe_u32 v8, v0, 8, 1
    v_lshl_or_b32 v100, v8, 2, v100
    s_mov_b32 s3, 8192
    v_mul_lo_u32 v100, v100, s3
    v_bfe_u32 v8, v0, 9, 1
    v_lshl_add_u32 v100, v8, 6, v100
    v_and_b32 v8, 0x30, v0
    s_lshr_b32 s3, s56, 1
    s_lshl_b32 s3, s3, 7
    v_add3_u32 v100, v100, v8, s3
    v_add_u32 v101, 64512, v100
    v_add_u32 v102, 129024, v100
    v_add_u32 v103, 193536, v100
    v_and_b32 v96, 0xf0, v0
    v_and_b32 v8, 0x300, v0
    v_lshl_or_b32 v96, v8, 2, v96
    s_and_b32 s3, s56, 1
    s_lshl_b32 s3, s3, 9
    v_or_b32 v96, s3, v96
    s_and_b32 s3, s56, 2
    s_lshl_b32 s3, s3, 15
    s_add_u32 s3, s3, 0x8000
    v_add_u32 v96, s3, v96
    v_add_u32 v97, 0x8000, v96
    s_and_b32 s3, s56, 1
    s_lshl_b32 s3, s3, 19
    s_lshl_b32 s71, s63, 8
    s_add_u32 s71, s71, s3
    s_add_u32 s3, s71, 0
    s_add_u32 m0, s61, 0
    s_nop 0
    buffer_load_dwordx4 v100, s[20:23], s3 offen offset:0 lds
    buffer_load_dwordx4 v101, s[20:23], s3 offen offset:1024 lds
    buffer_load_dwordx4 v102, s[20:23], s3 offen offset:2048 lds
    buffer_load_dwordx4 v103, s[20:23], s3 offen offset:3072 lds
    s_add_u32 m0, s61, 4096
    s_add_u32 s3, s3, 262144
    buffer_load_dwordx4 v100, s[20:23], s3 offen offset:0 lds
    buffer_load_dwordx4 v101, s[20:23], s3 offen offset:1024 lds
    buffer_load_dwordx4 v102, s[20:23], s3 offen offset:2048 lds
    buffer_load_dwordx4 v103, s[20:23], s3 offen offset:3072 lds
    s_add_u32 s3, s71, 1048576
    s_add_u32 m0, s61, 8192
    s_nop 0
    buffer_load_dwordx4 v100, s[20:23], s3 offen offset:0 lds
    buffer_load_dwordx4 v101, s[20:23], s3 offen offset:1024 lds
    buffer_load_dwordx4 v102, s[20:23], s3 offen offset:2048 lds
    buffer_load_dwordx4 v103, s[20:23], s3 offen offset:3072 lds
    s_add_u32 m0, s61, 12288
    s_add_u32 s3, s3, 262144
    buffer_load_dwordx4 v100, s[20:23], s3 offen offset:0 lds
    buffer_load_dwordx4 v101, s[20:23], s3 offen offset:1024 lds
    buffer_load_dwordx4 v102, s[20:23], s3 offen offset:2048 lds
    buffer_load_dwordx4 v103, s[20:23], s3 offen offset:3072 lds
    s_add_u32 s3, s71, 2097152
    s_add_u32 m0, s61, 16384
    s_nop 0
    buffer_load_dwordx4 v100, s[20:23], s3 offen offset:0 lds
    buffer_load_dwordx4 v101, s[20:23], s3 offen offset:1024 lds
    buffer_load_dwordx4 v102, s[20:23], s3 offen offset:2048 lds
    buffer_load_dwordx4 v103, s[20:23], s3 offen offset:3072 lds
    s_add_u32 m0, s61, 20480
    s_add_u32 s3, s3, 262144
    buffer_load_dwordx4 v100, s[20:23], s3 offen offset:0 lds
    buffer_load_dwordx4 v101, s[20:23], s3 offen offset:1024 lds
    buffer_load_dwordx4 v102, s[20:23], s3 offen offset:2048 lds
    buffer_load_dwordx4 v103, s[20:23], s3 offen offset:3072 lds
    s_add_u32 s3, s71, 3145728
    s_add_u32 m0, s61, 24576
    s_nop 0
    buffer_load_dwordx4 v100, s[20:23], s3 offen offset:0 lds
    buffer_load_dwordx4 v101, s[20:23], s3 offen offset:1024 lds
    buffer_load_dwordx4 v102, s[20:23], s3 offen offset:2048 lds
    buffer_load_dwordx4 v103, s[20:23], s3 offen offset:3072 lds
    s_add_u32 m0, s61, 28672
    s_add_u32 s3, s3, 262144
    buffer_load_dwordx4 v100, s[20:23], s3 offen offset:0 lds
    buffer_load_dwordx4 v101, s[20:23], s3 offen offset:1024 lds
    buffer_load_dwordx4 v102, s[20:23], s3 offen offset:2048 lds
    buffer_load_dwordx4 v103, s[20:23], s3 offen offset:3072 lds
    s_lshl_b32 s3, s62, 2
    s_add_u32 s3, s3, s56
    s_mul_i32 s3, s3, 5120
    s_add_u32 s4, s3, 4096
    buffer_load_dwordx4 v[124:127], v0, s[24:27], s3 offen offset:0
    buffer_load_dwordx4 v[124:127], v0, s[24:27], s3 offen offset:1024
    buffer_load_dwordx4 v[124:127], v0, s[24:27], s3 offen offset:2048
    buffer_load_dwordx4 v[124:127], v0, s[24:27], s3 offen offset:3072
    buffer_load_dwordx4 v[124:127], v0, s[24:27], s4 offen offset:0
    s_cmp_ge_u32 s62, 128
    s_cbranch_scc1 .ln7
    s_mov_b32 s6, 0xffff0000
    s_waitcnt vmcnt(37)
    v_lshlrev_b32 v32, 16, v16
    v_and_b32 v33, s6, v16
    v_lshlrev_b32 v34, 16, v17
    v_and_b32 v35, s6, v17
    v_lshlrev_b32 v36, 16, v18
    v_and_b32 v37, s6, v18
    v_lshlrev_b32 v38, 16, v19
    v_and_b32 v39, s6, v19
    v_lshlrev_b32 v40, 16, v20
    v_and_b32 v41, s6, v20
    v_lshlrev_b32 v42, 16, v21
    v_and_b32 v43, s6, v21
    v_lshlrev_b32 v44, 16, v22
    v_and_b32 v45, s6, v22
    v_lshlrev_b32 v46, 16, v23
    v_and_b32 v47, s6, v23
    v_lshlrev_b32 v48, 16, v24
    v_and_b32 v49, s6, v24
    v_lshlrev_b32 v50, 16, v25
    v_and_b32 v51, s6, v25
    v_lshlrev_b32 v52, 16, v26
    v_and_b32 v53, s6, v26
    v_lshlrev_b32 v54, 16, v27
    v_and_b32 v55, s6, v27
    v_lshlrev_b32 v56, 16, v28
    v_and_b32 v57, s6, v28
    v_lshlrev_b32 v58, 16, v29
    v_and_b32 v59, s6, v29
    v_lshlrev_b32 v60, 16, v30
    v_and_b32 v61, s6, v30
    v_lshlrev_b32 v62, 16, v31
    v_and_b32 v63, s6, v31
    v_add_f32 v8, v32, v36
    v_add_f32 v9, v33, v37
    v_add_f32 v10, v34, v38
    v_add_f32 v11, v35, v39
    v_add_f32 v8, v8, v40
    v_add_f32 v9, v9, v41
    v_add_f32 v10, v10, v42
    v_add_f32 v11, v11, v43
    v_add_f32 v8, v8, v44
    v_add_f32 v9, v9, v45
    v_add_f32 v10, v10, v46
    v_add_f32 v11, v11, v47
    v_add_f32 v8, v8, v48
    v_add_f32 v9, v9, v49
    v_add_f32 v10, v10, v50
    v_add_f32 v11, v11, v51
    v_add_f32 v8, v8, v52
    v_add_f32 v9, v9, v53
    v_add_f32 v10, v10, v54
    v_add_f32 v11, v11, v55
    v_add_f32 v8, v8, v56
    v_add_f32 v9, v9, v57
    v_add_f32 v10, v10, v58
    v_add_f32 v11, v11, v59
    v_add_f32 v8, v8, v60
    v_add_f32 v9, v9, v61
    v_add_f32 v10, v10, v62
    v_add_f32 v11, v11, v63
    v_add_f32 v8, v8, v9
    v_add_f32 v10, v10, v11
    v_add_f32 v8, v8, v10
    s_nop 1
    v_add_f32_dpp v8, v8, v8 row_ror:8 row_mask:0xf bank_mask:0xf
    s_nop 1
    v_add_f32_dpp v8, v8, v8 row_ror:4 row_mask:0xf bank_mask:0xf
    s_nop 1
    v_add_f32_dpp v8, v8, v8 row_ror:2 row_mask:0xf bank_mask:0xf
    s_nop 1
    v_add_f32_dpp v8, v8, v8 row_ror:1 row_mask:0xf bank_mask:0xf
    v_mul_f32 v8, 0.001953125, v8
    v_sub_f32 v64, v32, v8
    v_sub_f32 v65, v33, v8
    v_sub_f32 v66, v34, v8
    v_sub_f32 v67, v35, v8
    v_sub_f32 v68, v36, v8
    v_sub_f32 v69, v37, v8
    v_sub_f32 v70, v38, v8
    v_sub_f32 v71, v39, v8
    v_sub_f32 v72, v40, v8
    v_sub_f32 v73, v41, v8
    v_sub_f32 v74, v42, v8
    v_sub_f32 v75, v43, v8
    v_sub_f32 v76, v44, v8
    v_sub_f32 v77, v45, v8
    v_sub_f32 v78, v46, v8
    v_sub_f32 v79, v47, v8
    v_sub_f32 v80, v48, v8
    v_sub_f32 v81, v49, v8
    v_sub_f32 v82, v50, v8
    v_sub_f32 v83, v51, v8
    v_sub_f32 v84, v52, v8
    v_sub_f32 v85, v53, v8
    v_sub_f32 v86, v54, v8
    v_sub_f32 v87, v55, v8
    v_sub_f32 v88, v56, v8
    v_sub_f32 v89, v57, v8
    v_sub_f32 v90, v58, v8
    v_sub_f32 v91, v59, v8
    v_sub_f32 v92, v60, v8
    v_sub_f32 v93, v61, v8
    v_sub_f32 v94, v62, v8
    v_sub_f32 v95, v63, v8
    v_mul_f32 v10, v64, v64
    v_mul_f32 v11, v65, v65
    v_mul_f32 v12, v66, v66
    v_mul_f32 v13, v67, v67
    v_fmac_f32 v10, v68, v68
    v_fmac_f32 v11, v69, v69
    v_fmac_f32 v12, v70, v70
    v_fmac_f32 v13, v71, v71
    v_fmac_f32 v10, v72, v72
    v_fmac_f32 v11, v73, v73
    v_fmac_f32 v12, v74, v74
    v_fmac_f32 v13, v75, v75
    v_fmac_f32 v10, v76, v76
    v_fmac_f32 v11, v77, v77
    v_fmac_f32 v12, v78, v78
    v_fmac_f32 v13, v79, v79
    v_fmac_f32 v10, v80, v80
    v_fmac_f32 v11, v81, v81
    v_fmac_f32 v12, v82, v82
    v_fmac_f32 v13, v83, v83
    v_fmac_f32 v10, v84, v84
    v_fmac_f32 v11, v85, v85
    v_fmac_f32 v12, v86, v86
    v_fmac_f32 v13, v87, v87
    v_fmac_f32 v10, v88, v88
    v_fmac_f32 v11, v89, v89
    v_fmac_f32 v12, v90, v90
    v_fmac_f32 v13, v91, v91
    v_fmac_f32 v10, v92, v92
    v_fmac_f32 v11, v93, v93
    v_fmac_f32 v12, v94, v94
    v_fmac_f32 v13, v95, v95
    v_add_f32 v10, v10, v11
    v_add_f32 v12, v12, v13
    v_add_f32 v10, v10, v12
    s_nop 1
    v_add_f32_dpp v10, v10, v10 row_ror:8 row_mask:0xf bank_mask:0xf
    s_nop 1
    v_add_f32_dpp v10, v10, v10 row_ror:4 row_mask:0xf bank_mask:0xf
    s_nop 1
    v_add_f32_dpp v10, v10, v10 row_ror:2 row_mask:0xf bank_mask:0xf
    s_nop 1
    v_add_f32_dpp v10, v10, v10 row_ror:1 row_mask:0xf bank_mask:0xf
    v_mul_f32 v10, 0.001953125, v10
    v_cvt_pk_bf16_f32 v9, v8, v10
    v_lshlrev_b32 v8, 16, v9
    v_and_b32 v10, s6, v9
    v_add_f32 v10, 0x3727c5ac, v10
    v_cvt_pk_bf16_f32 v10, v10, v10
    v_and_b32 v10, s6, v10
    v_sqrt_f32 v10, v10
    s_nop 0
    v_cvt_pk_bf16_f32 v10, v10, v10
    v_and_b32 v10, s6, v10
    v_rcp_f32 v10, v10
    v_sub_f32 v64, v32, v8
    v_sub_f32 v65, v33, v8
    v_sub_f32 v66, v34, v8
    v_sub_f32 v67, v35, v8
    v_sub_f32 v68, v36, v8
    v_sub_f32 v69, v37, v8
    v_sub_f32 v70, v38, v8
    v_sub_f32 v71, v39, v8
    v_sub_f32 v72, v40, v8
    v_sub_f32 v73, v41, v8
    v_sub_f32 v74, v42, v8
    v_sub_f32 v75, v43, v8
    v_sub_f32 v76, v44, v8
    v_sub_f32 v77, v45, v8
    v_sub_f32 v78, v46, v8
    v_sub_f32 v79, v47, v8
    v_sub_f32 v80, v48, v8
    v_sub_f32 v81, v49, v8
    v_sub_f32 v82, v50, v8
    v_sub_f32 v83, v51, v8
    v_sub_f32 v84, v52, v8
    v_sub_f32 v85, v53, v8
    v_sub_f32 v86, v54, v8
    v_sub_f32 v87, v55, v8
    v_sub_f32 v88, v56, v8
    v_sub_f32 v89, v57, v8
    v_sub_f32 v90, v58, v8
    v_sub_f32 v91, v59, v8
    v_sub_f32 v92, v60, v8
    v_sub_f32 v93, v61, v8
    v_sub_f32 v94, v62, v8
    v_sub_f32 v95, v63, v8
    v_cvt_pk_bf16_f32 v16, v64, v65
    v_cvt_pk_bf16_f32 v17, v66, v67
    v_cvt_pk_bf16_f32 v18, v68, v69
    v_cvt_pk_bf16_f32 v19, v70, v71
    v_cvt_pk_bf16_f32 v20, v72, v73
    v_cvt_pk_bf16_f32 v21, v74, v75
    v_cvt_pk_bf16_f32 v22, v76, v77
    v_cvt_pk_bf16_f32 v23, v78, v79
    v_cvt_pk_bf16_f32 v24, v80, v81
    v_cvt_pk_bf16_f32 v25, v82, v83
    v_cvt_pk_bf16_f32 v26, v84, v85
    v_cvt_pk_bf16_f32 v27, v86, v87
    v_cvt_pk_bf16_f32 v28, v88, v89
    v_cvt_pk_bf16_f32 v29, v90, v91
    v_cvt_pk_bf16_f32 v30, v92, v93
    v_cvt_pk_bf16_f32 v31, v94, v95
    v_lshlrev_b32 v32, 16, v16
    v_and_b32 v33, s6, v16
    v_lshlrev_b32 v34, 16, v17
    v_and_b32 v35, s6, v17
    v_lshlrev_b32 v36, 16, v18
    v_and_b32 v37, s6, v18
    v_lshlrev_b32 v38, 16, v19
    v_and_b32 v39, s6, v19
    v_lshlrev_b32 v40, 16, v20
    v_and_b32 v41, s6, v20
    v_lshlrev_b32 v42, 16, v21
    v_and_b32 v43, s6, v21
    v_lshlrev_b32 v44, 16, v22
    v_and_b32 v45, s6, v22
    v_lshlrev_b32 v46, 16, v23
    v_and_b32 v47, s6, v23
    v_lshlrev_b32 v48, 16, v24
    v_and_b32 v49, s6, v24
    v_lshlrev_b32 v50, 16, v25
    v_and_b32 v51, s6, v25
    v_lshlrev_b32 v52, 16, v26
    v_and_b32 v53, s6, v26
    v_lshlrev_b32 v54, 16, v27
    v_and_b32 v55, s6, v27
    v_lshlrev_b32 v56, 16, v28
    v_and_b32 v57, s6, v28
    v_lshlrev_b32 v58, 16, v29
    v_and_b32 v59, s6, v29
    v_lshlrev_b32 v60, 16, v30
    v_and_b32 v61, s6, v30
    v_lshlrev_b32 v62, 16, v31
    v_and_b32 v63, s6, v31
    v_mul_f32 v32, v32, v10
    v_mul_f32 v33, v33, v10
    v_mul_f32 v34, v34, v10
    v_mul_f32 v35, v35, v10
    v_mul_f32 v36, v36, v10
    v_mul_f32 v37, v37, v10
    v_mul_f32 v38, v38, v10
    v_mul_f32 v39, v39, v10
    v_mul_f32 v40, v40, v10
    v_mul_f32 v41, v41, v10
    v_mul_f32 v42, v42, v10
    v_mul_f32 v43, v43, v10
    v_mul_f32 v44, v44, v10
    v_mul_f32 v45, v45, v10
    v_mul_f32 v46, v46, v10
    v_mul_f32 v47, v47, v10
    v_mul_f32 v48, v48, v10
    v_mul_f32 v49, v49, v10
    v_mul_f32 v50, v50, v10
    v_mul_f32 v51, v51, v10
    v_mul_f32 v52, v52, v10
    v_mul_f32 v53, v53, v10
    v_mul_f32 v54, v54, v10
    v_mul_f32 v55, v55, v10
    v_mul_f32 v56, v56, v10
    v_mul_f32 v57, v57, v10
    v_mul_f32 v58, v58, v10
    v_mul_f32 v59, v59, v10
    v_mul_f32 v60, v60, v10
    v_mul_f32 v61, v61, v10
    v_mul_f32 v62, v62, v10
    v_mul_f32 v63, v63, v10
    v_cvt_pk_bf16_f32 v16, v32, v33
    v_cvt_pk_bf16_f32 v17, v34, v35
    v_cvt_pk_bf16_f32 v18, v36, v37
    v_cvt_pk_bf16_f32 v19, v38, v39
    v_cvt_pk_bf16_f32 v20, v40, v41
    v_cvt_pk_bf16_f32 v21, v42, v43
    v_cvt_pk_bf16_f32 v22, v44, v45
    v_cvt_pk_bf16_f32 v23, v46, v47
    v_cvt_pk_bf16_f32 v24, v48, v49
    v_cvt_pk_bf16_f32 v25, v50, v51
    v_cvt_pk_bf16_f32 v26, v52, v53
    v_cvt_pk_bf16_f32 v27, v54, v55
    v_cvt_pk_bf16_f32 v28, v56, v57
    v_cvt_pk_bf16_f32 v29, v58, v59
    v_cvt_pk_bf16_f32 v30, v60, v61
    v_cvt_pk_bf16_f32 v31, v62, v63
    buffer_store_dwordx4 v[16:19], v6, s[52:55], s5 offen sc1
    s_add_u32 s5, s5, 8192
    buffer_store_dwordx4 v[20:23], v6, s[52:55], s5 offen sc1
    s_add_u32 s5, s5, 8192
    buffer_store_dwordx4 v[24:27], v6, s[52:55], s5 offen sc1
    s_add_u32 s5, s5, 8192
    buffer_store_dwordx4 v[28:31], v6, s[52:55], s5 offen sc1
.ln7:
    s_waitcnt vmcnt(0)
    s_barrier
    s_cmp_lg_u32 s56, 0
    s_cbranch_scc1 .ba8
    s_mov_b64 exec, 1
    v_mov_b32 v4, 1
    s_and_b32 s3, s57, 0xe0
    buffer_atomic_add v4, off, s[48:51], s3 offset:4 sc1
    s_mov_b64 exec, -1
.ba8:
    s_waitcnt vmcnt(24)
    s_barrier
    ds_read_b64_tr_b16 a[0:1], v96 offset:0
    ds_read_b64_tr_b16 a[2:3], v96 offset:256
    ds_read_b64_tr_b16 a[4:5], v96 offset:4096
    ds_read_b64_tr_b16 a[6:7], v96 offset:4352
    ds_read_b64_tr_b16 a[8:9], v96 offset:8
    ds_read_b64_tr_b16 a[10:11], v96 offset:264
    ds_read_b64_tr_b16 a[12:13], v96 offset:4104
    ds_read_b64_tr_b16 a[14:15], v96 offset:4360
    ds_read_b64_tr_b16 a[16:17], v97 offset:0
    ds_read_b64_tr_b16 a[18:19], v97 offset:256
    ds_read_b64_tr_b16 a[20:21], v97 offset:4096
    ds_read_b64_tr_b16 a[22:23], v97 offset:4352
    ds_read_b64_tr_b16 a[24:25], v97 offset:8
    ds_read_b64_tr_b16 a[26:27], v97 offset:264
    ds_read_b64_tr_b16 a[28:29], v97 offset:4104
    ds_read_b64_tr_b16 a[30:31], v97 offset:4360
    s_waitcnt lgkmcnt(0)
    s_barrier
    s_add_u32 s3, s71, 0
    s_add_u32 m0, s61, 0
    s_nop 0
    buffer_load_dwordx4 v100, s[24:27], s3 offen offset:0 lds
    buffer_load_dwordx4 v101, s[24:27], s3 offen offset:1024 lds
    buffer_load_dwordx4 v102, s[24:27], s3 offen offset:2048 lds
    buffer_load_dwordx4 v103, s[24:27], s3 offen offset:3072 lds
    s_add_u32 m0, s61, 4096
    s_add_u32 s3, s3, 262144
    buffer_load_dwordx4 v100, s[24:27], s3 offen offset:0 lds
    buffer_load_dwordx4 v101, s[24:27], s3 offen offset:1024 lds
    buffer_load_dwordx4 v102, s[24:27], s3 offen offset:2048 lds
    buffer_load_dwordx4 v103, s[24:27], s3 offen offset:3072 lds
    s_waitcnt vmcnt(24)
    s_barrier
    ds_read_b64_tr_b16 a[32:33], v96 offset:8192
    ds_read_b64_tr_b16 a[34:35], v96 offset:8448
    ds_read_b64_tr_b16 a[36:37], v96 offset:12288
    ds_read_b64_tr_b16 a[38:39], v96 offset:12544
    ds_read_b64_tr_b16 a[40:41], v96 offset:8200
    ds_read_b64_tr_b16 a[42:43], v96 offset:8456
    ds_read_b64_tr_b16 a[44:45], v96 offset:12296
    ds_read_b64_tr_b16 a[46:47], v96 offset:12552
    ds_read_b64_tr_b16 a[48:49], v97 offset:8192
    ds_read_b64_tr_b16 a[50:51], v97 offset:8448
    ds_read_b64_tr_b16 a[52:53], v97 offset:12288
    ds_read_b64_tr_b16 a[54:55], v97 offset:12544
    ds_read_b64_tr_b16 a[56:57], v97 offset:8200
    ds_read_b64_tr_b16 a[58:59], v97 offset:8456
    ds_read_b64_tr_b16 a[60:61], v97 offset:12296
    ds_read_b64_tr_b16 a[62:63], v97 offset:12552
    s_waitcnt lgkmcnt(0)
    s_barrier
    s_add_u32 s3, s71, 1048576
    s_add_u32 m0, s61, 8192
    s_nop 0
    buffer_load_dwordx4 v100, s[24:27], s3 offen offset:0 lds
    buffer_load_dwordx4 v101, s[24:27], s3 offen offset:1024 lds
    buffer_load_dwordx4 v102, s[24:27], s3 offen offset:2048 lds
    buffer_load_dwordx4 v103, s[24:27], s3 offen offset:3072 lds
    s_add_u32 m0, s61, 12288
    s_add_u32 s3, s3, 262144
    buffer_load_dwordx4 v100, s[24:27], s3 offen offset:0 lds
    buffer_load_dwordx4 v101, s[24:27], s3 offen offset:1024 lds
    buffer_load_dwordx4 v102, s[24:27], s3 offen offset:2048 lds
    buffer_load_dwordx4 v103, s[24:27], s3 offen offset:3072 lds
    s_waitcnt vmcnt(24)
    s_barrier
    ds_read_b64_tr_b16 a[64:65], v96 offset:16384
    ds_read_b64_tr_b16 a[66:67], v96 offset:16640
    ds_read_b64_tr_b16 a[68:69], v96 offset:20480
    ds_read_b64_tr_b16 a[70:71], v96 offset:20736
    ds_read_b64_tr_b16 a[72:73], v96 offset:16392
    ds_read_b64_tr_b16 a[74:75], v96 offset:16648
    ds_read_b64_tr_b16 a[76:77], v96 offset:20488
    ds_read_b64_tr_b16 a[78:79], v96 offset:20744
    ds_read_b64_tr_b16 a[80:81], v97 offset:16384
    ds_read_b64_tr_b16 a[82:83], v97 offset:16640
    ds_read_b64_tr_b16 a[84:85], v97 offset:20480
    ds_read_b64_tr_b16 a[86:87], v97 offset:20736
    ds_read_b64_tr_b16 a[88:89], v97 offset:16392
    ds_read_b64_tr_b16 a[90:91], v97 offset:16648
    ds_read_b64_tr_b16 a[92:93], v97 offset:20488
    ds_read_b64_tr_b16 a[94:95], v97 offset:20744
    s_waitcnt lgkmcnt(0)
    s_barrier
    s_add_u32 s3, s71, 2097152
    s_add_u32 m0, s61, 16384
    s_nop 0
    buffer_load_dwordx4 v100, s[24:27], s3 offen offset:0 lds
    buffer_load_dwordx4 v101, s[24:27], s3 offen offset:1024 lds
    buffer_load_dwordx4 v102, s[24:27], s3 offen offset:2048 lds
    buffer_load_dwordx4 v103, s[24:27], s3 offen offset:3072 lds
    s_add_u32 m0, s61, 20480
    s_add_u32 s3, s3, 262144
    buffer_load_dwordx4 v100, s[24:27], s3 offen offset:0 lds
    buffer_load_dwordx4 v101, s[24:27], s3 offen offset:1024 lds
    buffer_load_dwordx4 v102, s[24:27], s3 offen offset:2048 lds
    buffer_load_dwordx4 v103, s[24:27], s3 offen offset:3072 lds
    s_waitcnt vmcnt(24)
    s_barrier
    ds_read_b64_tr_b16 a[96:97], v96 offset:24576
    ds_read_b64_tr_b16 a[98:99], v96 offset:24832
    ds_read_b64_tr_b16 a[100:101], v96 offset:28672
    ds_read_b64_tr_b16 a[102:103], v96 offset:28928
    ds_read_b64_tr_b16 a[104:105], v96 offset:24584
    ds_read_b64_tr_b16 a[106:107], v96 offset:24840
    ds_read_b64_tr_b16 a[108:109], v96 offset:28680
    ds_read_b64_tr_b16 a[110:111], v96 offset:28936
    ds_read_b64_tr_b16 a[112:113], v97 offset:24576
    ds_read_b64_tr_b16 a[114:115], v97 offset:24832
    ds_read_b64_tr_b16 a[116:117], v97 offset:28672
    ds_read_b64_tr_b16 a[118:119], v97 offset:28928
    ds_read_b64_tr_b16 a[120:121], v97 offset:24584
    ds_read_b64_tr_b16 a[122:123], v97 offset:24840
    ds_read_b64_tr_b16 a[124:125], v97 offset:28680
    ds_read_b64_tr_b16 a[126:127], v97 offset:28936
    s_waitcnt lgkmcnt(0)
    s_barrier
    s_add_u32 s3, s71, 3145728
    s_add_u32 m0, s61, 24576
    s_nop 0
    buffer_load_dwordx4 v100, s[24:27], s3 offen offset:0 lds
    buffer_load_dwordx4 v101, s[24:27], s3 offen offset:1024 lds
    buffer_load_dwordx4 v102, s[24:27], s3 offen offset:2048 lds
    buffer_load_dwordx4 v103, s[24:27], s3 offen offset:3072 lds
    s_add_u32 m0, s61, 28672
    s_add_u32 s3, s3, 262144
    buffer_load_dwordx4 v100, s[24:27], s3 offen offset:0 lds
    buffer_load_dwordx4 v101, s[24:27], s3 offen offset:1024 lds
    buffer_load_dwordx4 v102, s[24:27], s3 offen offset:2048 lds
    buffer_load_dwordx4 v103, s[24:27], s3 offen offset:3072 lds
    s_waitcnt vmcnt(24)
    s_barrier
    ds_read_b64_tr_b16 a[128:129], v96 offset:0
    ds_read_b64_tr_b16 a[130:131], v96 offset:256
    ds_read_b64_tr_b16 a[132:133], v96 offset:4096
    ds_read_b64_tr_b16 a[134:135], v96 offset:4352
    ds_read_b64_tr_b16 a[136:137], v96 offset:8
    ds_read_b64_tr_b16 a[138:139], v96 offset:264
    ds_read_b64_tr_b16 a[140:141], v96 offset:4104
    ds_read_b64_tr_b16 a[142:143], v96 offset:4360
    ds_read_b64_tr_b16 a[144:145], v97 offset:0
    ds_read_b64_tr_b16 a[146:147], v97 offset:256
    ds_read_b64_tr_b16 a[148:149], v97 offset:4096
    ds_read_b64_tr_b16 a[150:151], v97 offset:4352
    ds_read_b64_tr_b16 a[152:153], v97 offset:8
    ds_read_b64_tr_b16 a[154:155], v97 offset:264
    ds_read_b64_tr_b16 a[156:157], v97 offset:4104
    ds_read_b64_tr_b16 a[158:159], v97 offset:4360
    v_and_b32 v8, 0x300, v0
    v_and_b32 v9, 0xf0, v0
    v_lshl_or_b32 v9, v8, 5, v9
    s_lshl_b32 s3, s64, 2
    s_add_u32 s3, s3, s56
    s_lshl_b32 s3, s3, 15
    s_lshl_b32 s4, s63, 8
    s_add_u32 s3, s3, s4
    s_add_u32 s4, s3, 0
    buffer_load_dwordx4 v[124:127], v9, s[16:19], s4 offen
    s_add_u32 s4, s3, 917504
    buffer_load_dwordx4 v[124:127], v9, s[16:19], s4 offen
    s_add_u32 s4, s3, 1835008
    buffer_load_dwordx4 v[124:127], v9, s[16:19], s4 offen
    s_add_u32 s4, s3, 2752512
    buffer_load_dwordx4 v[124:127], v9, s[16:19], s4 offen
    s_add_u32 s4, s3, 3670016
    buffer_load_dwordx4 v[124:127], v9, s[16:19], s4 offen
    s_waitcnt vmcnt(21)
    s_barrier
    ds_read_b64_tr_b16 a[160:161], v96 offset:8192
    ds_read_b64_tr_b16 a[162:163], v96 offset:8448
    ds_read_b64_tr_b16 a[164:165], v96 offset:12288
    ds_read_b64_tr_b16 a[166:167], v96 offset:12544
    ds_read_b64_tr_b16 a[168:169], v96 offset:8200
    ds_read_b64_tr_b16 a[170:171], v96 offset:8456
    ds_read_b64_tr_b16 a[172:173], v96 offset:12296
    ds_read_b64_tr_b16 a[174:175], v96 offset:12552
    ds_read_b64_tr_b16 a[176:177], v97 offset:8192
    ds_read_b64_tr_b16 a[178:179], v97 offset:8448
    ds_read_b64_tr_b16 a[180:181], v97 offset:12288
    ds_read_b64_tr_b16 a[182:183], v97 offset:12544
    ds_read_b64_tr_b16 a[184:185], v97 offset:8200
    ds_read_b64_tr_b16 a[186:187], v97 offset:8456
    ds_read_b64_tr_b16 a[188:189], v97 offset:12296
    ds_read_b64_tr_b16 a[190:191], v97 offset:12552
    s_waitcnt vmcnt(13)
    s_barrier
    ds_read_b64_tr_b16 a[192:193], v96 offset:16384
    ds_read_b64_tr_b16 a[194:195], v96 offset:16640
    ds_read_b64_tr_b16 a[196:197], v96 offset:20480
    ds_read_b64_tr_b16 a[198:199], v96 offset:20736
    ds_read_b64_tr_b16 a[200:201], v96 offset:16392
    ds_read_b64_tr_b16 a[202:203], v96 offset:16648
    ds_read_b64_tr_b16 a[204:205], v96 offset:20488
    ds_read_b64_tr_b16 a[206:207], v96 offset:20744
    ds_read_b64_tr_b16 a[208:209], v97 offset:16384
    ds_read_b64_tr_b16 a[210:211], v97 offset:16640
    ds_read_b64_tr_b16 a[212:213], v97 offset:20480
    ds_read_b64_tr_b16 a[214:215], v97 offset:20736
    ds_read_b64_tr_b16 a[216:217], v97 offset:16392
    ds_read_b64_tr_b16 a[218:219], v97 offset:16648
    ds_read_b64_tr_b16 a[220:221], v97 offset:20488
    ds_read_b64_tr_b16 a[222:223], v97 offset:20744
    s_waitcnt vmcnt(5)
    s_barrier
    ds_read_b64_tr_b16 a[224:225], v96 offset:24576
    ds_read_b64_tr_b16 a[226:227], v96 offset:24832
    ds_read_b64_tr_b16 a[228:229], v96 offset:28672
    ds_read_b64_tr_b16 a[230:231], v96 offset:28928
    ds_read_b64_tr_b16 a[232:233], v96 offset:24584
    ds_read_b64_tr_b16 a[234:235], v96 offset:24840
    ds_read_b64_tr_b16 a[236:237], v96 offset:28680
    ds_read_b64_tr_b16 a[238:239], v96 offset:28936
    ds_read_b64_tr_b16 a[240:241], v97 offset:24576
    ds_read_b64_tr_b16 a[242:243], v97 offset:24832
    ds_read_b64_tr_b16 a[244:245], v97 offset:28672
    ds_read_b64_tr_b16 a[246:247], v97 offset:28928
    ds_read_b64_tr_b16 a[248:249], v97 offset:24584
    ds_read_b64_tr_b16 a[250:251], v97 offset:24840
    ds_read_b64_tr_b16 a[252:253], v97 offset:28680
    ds_read_b64_tr_b16 a[254:255], v97 offset:28936
    s_waitcnt lgkmcnt(0)
    v_lshrrev_b32 v9, 2, v0
    s_mov_b32 s6, 0x02020202
    s_mov_b32 s7, 0x02020202
    s_mov_b32 s59, 40000
    s_cmp_lg_u32 s58, 0
    s_cselect_b32 s59, 1, s59
.spin9:
    buffer_load_dword v8, v9, s[48:51], 0 offen sc1
    s_waitcnt vmcnt(0)
    v_cmp_eq_u32 vcc, 32, v8
    s_and_b64 s[4:5], vcc, s[6:7]
    s_cmp_eq_u64 s[4:5], s[6:7]
    s_cbranch_scc1 .spinx10
    s_sub_u32 s59, s59, 1
    s_cmp_lg_u32 s59, 0
    s_cbranch_scc1 .spin9
    s_mov_b32 s58, 1
.spinx10:
    s_barrier
    s_mov_b32 s65, s64
    s_mov_b32 s66, 0
    s_lshl_b32 s3, s65, 15
    s_lshl_b32 s4, s56, 13
    s_add_u32 s3, s3, s4
    s_add_u32 m0, s66, s4
    s_nop 0
    buffer_load_dwordx4 v0, s[52:55], s3 offen offset:0 sc1 lds
    buffer_load_dwordx4 v0, s[52:55], s3 offen offset:1024 sc1 lds
    buffer_load_dwordx4 v0, s[52:55], s3 offen offset:2048 sc1 lds
    buffer_load_dwordx4 v0, s[52:55], s3 offen offset:3072 sc1 lds
    s_add_u32 m0, m0, 4096
    s_add_u32 s3, s3, 4096
    buffer_load_dwordx4 v0, s[52:55], s3 offen offset:0 sc1 lds
    buffer_load_dwordx4 v0, s[52:55], s3 offen offset:1024 sc1 lds
    buffer_load_dwordx4 v0, s[52:55], s3 offen offset:2048 sc1 lds
    buffer_load_dwordx4 v0, s[52:55], s3 offen offset:3072 sc1 lds
    v_mov_b32 v2, v0
    v_mov_b32 v3, 1
    s_mov_b32 s68, 1072693248
    s_waitcnt vmcnt(0)
.qkv11:
    s_waitcnt vmcnt(5)
    s_barrier
    s_add_u32 s67, s65, 7
    s_cmp_eq_u32 s67, 63
    s_cselect_b32 s3, 71, s67
    s_cmp_eq_u32 s67, 64
    s_cselect_b32 s67, 63, s3
    s_xor_b32 s66, s66, 0x8000
    s_lshl_b32 s3, s67, 15
    s_lshl_b32 s4, s56, 13
    s_add_u32 s3, s3, s4
    s_add_u32 m0, s66, s4
    s_nop 0
    buffer_load_dwordx4 v0, s[52:55], s3 offen offset:0 sc1 lds
    buffer_load_dwordx4 v0, s[52:55], s3 offen offset:1024 sc1 lds
    buffer_load_dwordx4 v0, s[52:55], s3 offen offset:2048 sc1 lds
    buffer_load_dwordx4 v0, s[52:55], s3 offen offset:3072 sc1 lds
    s_add_u32 m0, m0, 4096
    s_add_u32 s3, s3, 4096
    buffer_load_dwordx4 v0, s[52:55], s3 offen offset:0 sc1 lds
    buffer_load_dwordx4 v0, s[52:55], s3 offen offset:1024 sc1 lds
    buffer_load_dwordx4 v0, s[52:55], s3 offen offset:2048 sc1 lds
    buffer_load_dwordx4 v0, s[52:55], s3 offen offset:3072 sc1 lds
    ds_read_b128 v[16:19], v2 offset:0
    ds_read_b128 v[20:23], v2 offset:1024
    ds_read_b128 v[24:27], v2 offset:2048
    ds_read_b128 v[28:31], v2 offset:3072
    ds_read_b128 v[32:35], v2 offset:4096
    ds_read_b128 v[36:39], v2 offset:5120
    ds_read_b128 v[40:43], v2 offset:6144
    ds_read_b128 v[44:47], v2 offset:7168
    s_waitcnt lgkmcnt(6)
    v_mfma_f32_16x16x32_bf16 v[64:67], a[0:3], v[16:19], 0
    v_mfma_f32_16x16x32_bf16 v[68:71], a[0:3], v[20:23], 0
    v_mfma_f32_16x16x32_bf16 v[72:75], a[8:11], v[16:19], 0
    v_mfma_f32_16x16x32_bf16 v[76:79], a[8:11], v[20:23], 0
    v_mfma_f32_16x16x32_bf16 v[80:83], v[16:19], a[128:131], 0
    v_mfma_f32_16x16x32_bf16 v[84:87], v[20:23], a[128:131], 0
    v_mfma_f32_16x16x32_bf16 v[88:91], v[16:19], a[136:139], 0
    v_mfma_f32_16x16x32_bf16 v[92:95], v[20:23], a[136:139], 0
    ds_read_b128 v[16:19], v2 offset:8192
    ds_read_b128 v[20:23], v2 offset:9216
    s_waitcnt lgkmcnt(6)
    v_mfma_f32_16x16x32_bf16 v[64:67], a[4:7], v[24:27], v[64:67]
    v_mfma_f32_16x16x32_bf16 v[68:71], a[4:7], v[28:31], v[68:71]
    v_mfma_f32_16x16x32_bf16 v[72:75], a[12:15], v[24:27], v[72:75]
    v_mfma_f32_16x16x32_bf16 v[76:79], a[12:15], v[28:31], v[76:79]
    v_mfma_f32_16x16x32_bf16 v[80:83], v[24:27], a[132:135], v[80:83]
    v_mfma_f32_16x16x32_bf16 v[84:87], v[28:31], a[132:135], v[84:87]
    v_mfma_f32_16x16x32_bf16 v[88:91], v[24:27], a[140:143], v[88:91]
    v_mfma_f32_16x16x32_bf16 v[92:95], v[28:31], a[140:143], v[92:95]
    ds_read_b128 v[24:27], v2 offset:10240
    ds_read_b128 v[28:31], v2 offset:11264
    s_waitcnt lgkmcnt(6)
    v_mfma_f32_16x16x32_bf16 v[64:67], a[16:19], v[32:35], v[64:67]
    v_mfma_f32_16x16x32_bf16 v[68:71], a[16:19], v[36:39], v[68:71]
    v_mfma_f32_16x16x32_bf16 v[72:75], a[24:27], v[32:35], v[72:75]
    v_mfma_f32_16x16x32_bf16 v[76:79], a[24:27], v[36:39], v[76:79]
    v_mfma_f32_16x16x32_bf16 v[80:83], v[32:35], a[144:147], v[80:83]
    v_mfma_f32_16x16x32_bf16 v[84:87], v[36:39], a[144:147], v[84:87]
    v_mfma_f32_16x16x32_bf16 v[88:91], v[32:35], a[152:155], v[88:91]
    v_mfma_f32_16x16x32_bf16 v[92:95], v[36:39], a[152:155], v[92:95]
    ds_read_b128 v[32:35], v2 offset:12288
    ds_read_b128 v[36:39], v2 offset:13312
    s_waitcnt lgkmcnt(6)
    v_mfma_f32_16x16x32_bf16 v[64:67], a[20:23], v[40:43], v[64:67]
    v_mfma_f32_16x16x32_bf16 v[68:71], a[20:23], v[44:47], v[68:71]
    v_mfma_f32_16x16x32_bf16 v[72:75], a[28:31], v[40:43], v[72:75]
    v_mfma_f32_16x16x32_bf16 v[76:79], a[28:31], v[44:47], v[76:79]
    v_mfma_f32_16x16x32_bf16 v[80:83], v[40:43], a[148:151], v[80:83]
    v_mfma_f32_16x16x32_bf16 v[84:87], v[44:47], a[148:151], v[84:87]
    v_mfma_f32_16x16x32_bf16 v[88:91], v[40:43], a[156:159], v[88:91]
    v_mfma_f32_16x16x32_bf16 v[92:95], v[44:47], a[156:159], v[92:95]
    ds_read_b128 v[40:43], v2 offset:14336
    ds_read_b128 v[44:47], v2 offset:15360
    s_waitcnt lgkmcnt(6)
    v_mfma_f32_16x16x32_bf16 v[64:67], a[32:35], v[16:19], v[64:67]
    v_mfma_f32_16x16x32_bf16 v[68:71], a[32:35], v[20:23], v[68:71]
    v_mfma_f32_16x16x32_bf16 v[72:75], a[40:43], v[16:19], v[72:75]
    v_mfma_f32_16x16x32_bf16 v[76:79], a[40:43], v[20:23], v[76:79]
    v_mfma_f32_16x16x32_bf16 v[80:83], v[16:19], a[160:163], v[80:83]
    v_mfma_f32_16x16x32_bf16 v[84:87], v[20:23], a[160:163], v[84:87]
    v_mfma_f32_16x16x32_bf16 v[88:91], v[16:19], a[168:171], v[88:91]
    v_mfma_f32_16x16x32_bf16 v[92:95], v[20:23], a[168:171], v[92:95]
    ds_read_b128 v[16:19], v2 offset:16384
    ds_read_b128 v[20:23], v2 offset:17408
    s_waitcnt lgkmcnt(6)
    v_mfma_f32_16x16x32_bf16 v[64:67], a[36:39], v[24:27], v[64:67]
    v_mfma_f32_16x16x32_bf16 v[68:71], a[36:39], v[28:31], v[68:71]
    v_mfma_f32_16x16x32_bf16 v[72:75], a[44:47], v[24:27], v[72:75]
    v_mfma_f32_16x16x32_bf16 v[76:79], a[44:47], v[28:31], v[76:79]
    v_mfma_f32_16x16x32_bf16 v[80:83], v[24:27], a[164:167], v[80:83]
    v_mfma_f32_16x16x32_bf16 v[84:87], v[28:31], a[164:167], v[84:87]
    v_mfma_f32_16x16x32_bf16 v[88:91], v[24:27], a[172:175], v[88:91]
    v_mfma_f32_16x16x32_bf16 v[92:95], v[28:31], a[172:175], v[92:95]
    ds_read_b128 v[24:27], v2 offset:18432
    ds_read_b128 v[28:31], v2 offset:19456
    s_waitcnt lgkmcnt(6)
    v_mfma_f32_16x16x32_bf16 v[64:67], a[48:51], v[32:35], v[64:67]
    v_mfma_f32_16x16x32_bf16 v[68:71], a[48:51], v[36:39], v[68:71]
    v_mfma_f32_16x16x32_bf16 v[72:75], a[56:59], v[32:35], v[72:75]
    v_mfma_f32_16x16x32_bf16 v[76:79], a[56:59], v[36:39], v[76:79]
    v_mfma_f32_16x16x32_bf16 v[80:83], v[32:35], a[176:179], v[80:83]
    v_mfma_f32_16x16x32_bf16 v[84:87], v[36:39], a[176:179], v[84:87]
    v_mfma_f32_16x16x32_bf16 v[88:91], v[32:35], a[184:187], v[88:91]
    v_mfma_f32_16x16x32_bf16 v[92:95], v[36:39], a[184:187], v[92:95]
    ds_read_b128 v[32:35], v2 offset:20480
    ds_read_b128 v[36:39], v2 offset:21504
    s_waitcnt lgkmcnt(6)
    v_mfma_f32_16x16x32_bf16 v[64:67], a[52:55], v[40:43], v[64:67]
    v_mfma_f32_16x16x32_bf16 v[68:71], a[52:55], v[44:47], v[68:71]
    v_mfma_f32_16x16x32_bf16 v[72:75], a[60:63], v[40:43], v[72:75]
    v_mfma_f32_16x16x32_bf16 v[76:79], a[60:63], v[44:47], v[76:79]
    v_mfma_f32_16x16x32_bf16 v[80:83], v[40:43], a[180:183], v[80:83]
    v_mfma_f32_16x16x32_bf16 v[84:87], v[44:47], a[180:183], v[84:87]
    v_mfma_f32_16x16x32_bf16 v[88:91], v[40:43], a[188:191], v[88:91]
    v_mfma_f32_16x16x32_bf16 v[92:95], v[44:47], a[188:191], v[92:95]
    ds_read_b128 v[40:43], v2 offset:22528
    ds_read_b128 v[44:47], v2 offset:23552
    s_waitcnt lgkmcnt(6)
    v_mfma_f32_16x16x32_bf16 v[64:67], a[64:67], v[16:19], v[64:67]
    v_mfma_f32_16x16x32_bf16 v[68:71], a[64:67], v[20:23], v[68:71]
    v_mfma_f32_16x16x32_bf16 v[72:75], a[72:75], v[16:19], v[72:75]
    v_mfma_f32_16x16x32_bf16 v[76:79], a[72:75], v[20:23], v[76:79]
    v_mfma_f32_16x16x32_bf16 v[80:83], v[16:19], a[192:195], v[80:83]
    v_mfma_f32_16x16x32_bf16 v[84:87], v[20:23], a[192:195], v[84:87]
    v_mfma_f32_16x16x32_bf16 v[88:91], v[16:19], a[200:203], v[88:91]
    v_mfma_f32_16x16x32_bf16 v[92:95], v[20:23], a[200:203], v[92:95]
    s_waitcnt vmcnt(8)
    s_mov_b64 exec, 1
    buffer_store_byte v3, off, s[52:55], s68 sc1
    s_mov_b64 exec, -1
    ds_read_b128 v[16:19], v2 offset:24576
    ds_read_b128 v[20:23], v2 offset:25600
    s_waitcnt lgkmcnt(6)
    v_mfma_f32_16x16x32_bf16 v[64:67], a[68:71], v[24:27], v[64:67]
    v_mfma_f32_16x16x32_bf16 v[68:71], a[68:71], v[28:31], v[68:71]
    v_mfma_f32_16x16x32_bf16 v[72:75], a[76:79], v[24:27], v[72:75]
    v_mfma_f32_16x16x32_bf16 v[76:79], a[76:79], v[28:31], v[76:79]
    v_mfma_f32_16x16x32_bf16 v[80:83], v[24:27], a[196:199], v[80:83]
    v_mfma_f32_16x16x32_bf16 v[84:87], v[28:31], a[196:199], v[84:87]
    v_mfma_f32_16x16x32_bf16 v[88:91], v[24:27], a[204:207], v[88:91]
    v_mfma_f32_16x16x32_bf16 v[92:95], v[28:31], a[204:207], v[92:95]
    ds_read_b128 v[24:27], v2 offset:26624
    ds_read_b128 v[28:31], v2 offset:27648
    s_waitcnt lgkmcnt(6)
    v_mfma_f32_16x16x32_bf16 v[64:67], a[80:83], v[32:35], v[64:67]
    v_mfma_f32_16x16x32_bf16 v[68:71], a[80:83], v[36:39], v[68:71]
    v_mfma_f32_16x16x32_bf16 v[72:75], a[88:91], v[32:35], v[72:75]
    v_mfma_f32_16x16x32_bf16 v[76:79], a[88:91], v[36:39], v[76:79]
    v_mfma_f32_16x16x32_bf16 v[80:83], v[32:35], a[208:211], v[80:83]
    v_mfma_f32_16x16x32_bf16 v[84:87], v[36:39], a[208:211], v[84:87]
    v_mfma_f32_16x16x32_bf16 v[88:91], v[32:35], a[216:219], v[88:91]
    v_mfma_f32_16x16x32_bf16 v[92:95], v[36:39], a[216:219], v[92:95]
    ds_read_b128 v[32:35], v2 offset:28672
    ds_read_b128 v[36:39], v2 offset:29696
    s_waitcnt lgkmcnt(6)
    v_mfma_f32_16x16x32_bf16 v[64:67], a[84:87], v[40:43], v[64:67]
    v_mfma_f32_16x16x32_bf16 v[68:71], a[84:87], v[44:47], v[68:71]
    v_mfma_f32_16x16x32_bf16 v[72:75], a[92:95], v[40:43], v[72:75]
    v_mfma_f32_16x16x32_bf16 v[76:79], a[92:95], v[44:47], v[76:79]
    v_mfma_f32_16x16x32_bf16 v[80:83], v[40:43], a[212:215], v[80:83]
    v_mfma_f32_16x16x32_bf16 v[84:87], v[44:47], a[212:215], v[84:87]
    v_mfma_f32_16x16x32_bf16 v[88:91], v[40:43], a[220:223], v[88:91]
    v_mfma_f32_16x16x32_bf16 v[92:95], v[44:47], a[220:223], v[92:95]
    ds_read_b128 v[40:43], v2 offset:30720
    ds_read_b128 v[44:47], v2 offset:31744
    s_waitcnt lgkmcnt(6)
    v_mfma_f32_16x16x32_bf16 v[64:67], a[96:99], v[16:19], v[64:67]
    v_mfma_f32_16x16x32_bf16 v[68:71], a[96:99], v[20:23], v[68:71]
    v_mfma_f32_16x16x32_bf16 v[72:75], a[104:107], v[16:19], v[72:75]
    v_mfma_f32_16x16x32_bf16 v[76:79], a[104:107], v[20:23], v[76:79]
    v_mfma_f32_16x16x32_bf16 v[80:83], v[16:19], a[224:227], v[80:83]
    v_mfma_f32_16x16x32_bf16 v[84:87], v[20:23], a[224:227], v[84:87]
    v_mfma_f32_16x16x32_bf16 v[88:91], v[16:19], a[232:235], v[88:91]
    v_mfma_f32_16x16x32_bf16 v[92:95], v[20:23], a[232:235], v[92:95]
    s_waitcnt lgkmcnt(4)
    v_mfma_f32_16x16x32_bf16 v[64:67], a[100:103], v[24:27], v[64:67]
    v_mfma_f32_16x16x32_bf16 v[68:71], a[100:103], v[28:31], v[68:71]
    v_mfma_f32_16x16x32_bf16 v[72:75], a[108:111], v[24:27], v[72:75]
    v_mfma_f32_16x16x32_bf16 v[76:79], a[108:111], v[28:31], v[76:79]
    v_mfma_f32_16x16x32_bf16 v[80:83], v[24:27], a[228:231], v[80:83]
    v_mfma_f32_16x16x32_bf16 v[84:87], v[28:31], a[228:231], v[84:87]
    v_mfma_f32_16x16x32_bf16 v[88:91], v[24:27], a[236:239], v[88:91]
    v_mfma_f32_16x16x32_bf16 v[92:95], v[28:31], a[236:239], v[92:95]
    s_waitcnt lgkmcnt(2)
    v_mfma_f32_16x16x32_bf16 v[64:67], a[112:115], v[32:35], v[64:67]
    v_mfma_f32_16x16x32_bf16 v[68:71], a[112:115], v[36:39], v[68:71]
    v_mfma_f32_16x16x32_bf16 v[72:75], a[120:123], v[32:35], v[72:75]
    v_mfma_f32_16x16x32_bf16 v[76:79], a[120:123], v[36:39], v[76:79]
    v_mfma_f32_16x16x32_bf16 v[80:83], v[32:35], a[240:243], v[80:83]
    v_mfma_f32_16x16x32_bf16 v[84:87], v[36:39], a[240:243], v[84:87]
    v_mfma_f32_16x16x32_bf16 v[88:91], v[32:35], a[248:251], v[88:91]
    v_mfma_f32_16x16x32_bf16 v[92:95], v[36:39], a[248:251], v[92:95]
    s_waitcnt lgkmcnt(0)
    v_mfma_f32_16x16x32_bf16 v[64:67], a[116:119], v[40:43], v[64:67]
    v_mfma_f32_16x16x32_bf16 v[68:71], a[116:119], v[44:47], v[68:71]
    v_mfma_f32_16x16x32_bf16 v[72:75], a[124:127], v[40:43], v[72:75]
    v_mfma_f32_16x16x32_bf16 v[76:79], a[124:127], v[44:47], v[76:79]
    v_mfma_f32_16x16x32_bf16 v[80:83], v[40:43], a[244:247], v[80:83]
    v_mfma_f32_16x16x32_bf16 v[84:87], v[44:47], a[244:247], v[84:87]
    v_mfma_f32_16x16x32_bf16 v[88:91], v[40:43], a[252:255], v[88:91]
    v_mfma_f32_16x16x32_bf16 v[92:95], v[44:47], a[252:255], v[92:95]
    s_lshl_b32 s3, s63, 6
    s_add_u32 s3, s3, s65
    s_lshl_b32 s68, s3, 2
    s_add_u32 s68, s68, s56
    s_add_u32 s68, s68, 167772160
    s_mul_i32 s3, s63, 24576
    s_mul_i32 s4, s65, 786432
    s_add_u32 s3, s3, s4
    s_lshl_b32 s4, s56, 10
    s_add_u32 s3, s3, s4
    s_add_u32 s3, s3, 2097152
    s_add_u32 s4, s3, s4
    v_cvt_pk_bf16_f32 v104, v64, v65
    v_cvt_pk_bf16_f32 v105, v66, v67
    v_cvt_pk_bf16_f32 v106, v72, v73
    v_cvt_pk_bf16_f32 v107, v74, v75
    s_add_u32 s5, s3, 0
    buffer_store_dwordx4 v[104:107], v0, s[52:55], s5 offen sc1
    v_cvt_pk_bf16_f32 v108, v68, v69
    v_cvt_pk_bf16_f32 v109, v70, v71
    v_cvt_pk_bf16_f32 v110, v76, v77
    v_cvt_pk_bf16_f32 v111, v78, v79
    s_add_u32 s5, s3, 4096
    buffer_store_dwordx4 v[108:111], v0, s[52:55], s5 offen sc1
    v_cvt_pk_bf16_f32 v112, v80, v81
    v_cvt_pk_bf16_f32 v113, v82, v83
    v_cvt_pk_bf16_f32 v114, v84, v85
    v_cvt_pk_bf16_f32 v115, v86, v87
    s_add_u32 s5, s4, 8192
    buffer_store_dwordx4 v[112:115], v0, s[52:55], s5 offen sc1
    v_cvt_pk_bf16_f32 v116, v92, v93
    v_cvt_pk_bf16_f32 v117, v94, v95
    v_cvt_pk_bf16_f32 v118, v88, v89
    v_cvt_pk_bf16_f32 v119, v90, v91
    s_add_u32 s5, s4, 9216
    buffer_store_dwordx4 v[116:119], v0, s[52:55], s5 offen sc1
    v_xor_b32 v2, 0x8000, v2
    s_mov_b32 s65, s67
    s_cmp_lt_u32 s65, 64
    s_cbranch_scc1 .qkv11
    s_waitcnt vmcnt(0)
    s_mov_b64 exec, 1
    buffer_store_byte v3, off, s[52:55], s68 sc1
    s_mov_b64 exec, -1
    s_barrier
    s_lshl_b32 s3, s62, 2
    s_add_u32 s3, s3, s56
    s_lshl_b32 s3, s3, 11
    buffer_load_dwordx4 v[124:127], v0, s[32:35], s3 offen offset:0
    buffer_load_dwordx4 v[124:127], v0, s[32:35], s3 offen offset:1024
    buffer_load_dwordx4 v[124:127], v0, s[36:39], s3 offen offset:0
    buffer_load_dwordx4 v[124:127], v0, s[36:39], s3 offen offset:1024
    buffer_load_dwordx4 v[124:127], v0, s[40:43], s3 offen offset:0
    buffer_load_dwordx4 v[124:127], v0, s[40:43], s3 offen offset:1024
    s_add_u32 s3, s71, 0
    s_add_u32 m0, s61, 0
    s_nop 0
    buffer_load_dwordx4 v100, s[16:19], s3 offen offset:0 lds
    buffer_load_dwordx4 v101, s[16:19], s3 offen offset:1024 lds
    buffer_load_dwordx4 v102, s[16:19], s3 offen offset:2048 lds
    buffer_load_dwordx4 v103, s[16:19], s3 offen offset:3072 lds
    s_add_u32 m0, s61, 4096
    s_add_u32 s3, s3, 262144
    buffer_load_dwordx4 v100, s[16:19], s3 offen offset:0 lds
    buffer_load_dwordx4 v101, s[16:19], s3 offen offset:1024 lds
    buffer_load_dwordx4 v102, s[16:19], s3 offen offset:2048 lds
    buffer_load_dwordx4 v103, s[16:19], s3 offen offset:3072 lds
    s_add_u32 s3, s71, 1048576
    s_add_u32 m0, s61, 8192
    s_nop 0
    buffer_load_dwordx4 v100, s[16:19], s3 offen offset:0 lds
    buffer_load_dwordx4 v101, s[16:19], s3 offen offset:1024 lds
    buffer_load_dwordx4 v102, s[16:19], s3 offen offset:2048 lds
    buffer_load_dwordx4 v103, s[16:19], s3 offen offset:3072 lds
    s_add_u32 m0, s61, 12288
    s_add_u32 s3, s3, 262144
    buffer_load_dwordx4 v100, s[16:19], s3 offen offset:0 lds
    buffer_load_dwordx4 v101, s[16:19], s3 offen offset:1024 lds
    buffer_load_dwordx4 v102, s[16:19], s3 offen offset:2048 lds
    buffer_load_dwordx4 v103, s[16:19], s3 offen offset:3072 lds
    s_add_u32 s3, s71, 2097152
    s_add_u32 m0, s61, 16384
    s_nop 0
    buffer_load_dwordx4 v100, s[16:19], s3 offen offset:0 lds
    buffer_load_dwordx4 v101, s[16:19], s3 offen offset:1024 lds
    buffer_load_dwordx4 v102, s[16:19], s3 offen offset:2048 lds
    buffer_load_dwordx4 v103, s[16:19], s3 offen offset:3072 lds
    s_add_u32 m0, s61, 20480
    s_add_u32 s3, s3, 262144
    buffer_load_dwordx4 v100, s[16:19], s3 offen offset:0 lds
    buffer_load_dwordx4 v101, s[16:19], s3 offen offset:1024 lds
    buffer_load_dwordx4 v102, s[16:19], s3 offen offset:2048 lds
    buffer_load_dwordx4 v103, s[16:19], s3 offen offset:3072 lds
    s_add_u32 s3, s71, 3145728
    s_add_u32 m0, s61, 24576
    s_nop 0
    buffer_load_dwordx4 v100, s[16:19], s3 offen offset:0 lds
    buffer_load_dwordx4 v101, s[16:19], s3 offen offset:1024 lds
    buffer_load_dwordx4 v102, s[16:19], s3 offen offset:2048 lds
    buffer_load_dwordx4 v103, s[16:19], s3 offen offset:3072 lds
    s_add_u32 m0, s61, 28672
    s_add_u32 s3, s3, 262144
    buffer_load_dwordx4 v100, s[16:19], s3 offen offset:0 lds
    buffer_load_dwordx4 v101, s[16:19], s3 offen offset:1024 lds
    buffer_load_dwordx4 v102, s[16:19], s3 offen offset:2048 lds
    buffer_load_dwordx4 v103, s[16:19], s3 offen offset:3072 lds
    s_waitcnt vmcnt(24)
    s_barrier
    ds_read_b64_tr_b16 v[128:129], v96 offset:0
    ds_read_b64_tr_b16 v[130:131], v96 offset:256
    ds_read_b64_tr_b16 v[132:133], v96 offset:4096
    ds_read_b64_tr_b16 v[134:135], v96 offset:4352
    ds_read_b64_tr_b16 v[136:137], v96 offset:8
    ds_read_b64_tr_b16 v[138:139], v96 offset:264
    ds_read_b64_tr_b16 v[140:141], v96 offset:4104
    ds_read_b64_tr_b16 v[142:143], v96 offset:4360
    ds_read_b64_tr_b16 v[144:145], v97 offset:0
    ds_read_b64_tr_b16 v[146:147], v97 offset:256
    ds_read_b64_tr_b16 v[148:149], v97 offset:4096
    ds_read_b64_tr_b16 v[150:151], v97 offset:4352
    ds_read_b64_tr_b16 v[152:153], v97 offset:8
    ds_read_b64_tr_b16 v[154:155], v97 offset:264
    ds_read_b64_tr_b16 v[156:157], v97 offset:4104
    ds_read_b64_tr_b16 v[158:159], v97 offset:4360
    s_waitcnt vmcnt(16)
    s_barrier
    ds_read_b64_tr_b16 v[160:161], v96 offset:8192
    ds_read_b64_tr_b16 v[162:163], v96 offset:8448
    ds_read_b64_tr_b16 v[164:165], v96 offset:12288
    ds_read_b64_tr_b16 v[166:167], v96 offset:12544
    ds_read_b64_tr_b16 v[168:169], v96 offset:8200
    ds_read_b64_tr_b16 v[170:171], v96 offset:8456
    ds_read_b64_tr_b16 v[172:173], v96 offset:12296
    ds_read_b64_tr_b16 v[174:175], v96 offset:12552
    ds_read_b64_tr_b16 v[176:177], v97 offset:8192
    ds_read_b64_tr_b16 v[178:179], v97 offset:8448
    ds_read_b64_tr_b16 v[180:181], v97 offset:12288
    ds_read_b64_tr_b16 v[182:183], v97 offset:12544
    ds_read_b64_tr_b16 v[184:185], v97 offset:8200
    ds_read_b64_tr_b16 v[186:187], v97 offset:8456
    ds_read_b64_tr_b16 v[188:189], v97 offset:12296
    ds_read_b64_tr_b16 v[190:191], v97 offset:12552
    s_waitcnt vmcnt(8)
    s_barrier
    ds_read_b64_tr_b16 v[192:193], v96 offset:16384
    ds_read_b64_tr_b16 v[194:195], v96 offset:16640
    ds_read_b64_tr_b16 v[196:197], v96 offset:20480
    ds_read_b64_tr_b16 v[198:199], v96 offset:20736
    ds_read_b64_tr_b16 v[200:201], v96 offset:16392
    ds_read_b64_tr_b16 v[202:203], v96 offset:16648
    ds_read_b64_tr_b16 v[204:205], v96 offset:20488
    ds_read_b64_tr_b16 v[206:207], v96 offset:20744
    ds_read_b64_tr_b16 v[208:209], v97 offset:16384
    ds_read_b64_tr_b16 v[210:211], v97 offset:16640
    ds_read_b64_tr_b16 v[212:213], v97 offset:20480
    ds_read_b64_tr_b16 v[214:215], v97 offset:20736
    ds_read_b64_tr_b16 v[216:217], v97 offset:16392
    ds_read_b64_tr_b16 v[218:219], v97 offset:16648
    ds_read_b64_tr_b16 v[220:221], v97 offset:20488
    ds_read_b64_tr_b16 v[222:223], v97 offset:20744
    s_waitcnt vmcnt(0)
    s_barrier
    ds_read_b64_tr_b16 v[224:225], v96 offset:24576
    ds_read_b64_tr_b16 v[226:227], v96 offset:24832
    ds_read_b64_tr_b16 v[228:229], v96 offset:28672
    ds_read_b64_tr_b16 v[230:231], v96 offset:28928
    ds_read_b64_tr_b16 v[232:233], v96 offset:24584
    ds_read_b64_tr_b16 v[234:235], v96 offset:24840
    ds_read_b64_tr_b16 v[236:237], v96 offset:28680
    ds_read_b64_tr_b16 v[238:239], v96 offset:28936
    ds_read_b64_tr_b16 v[240:241], v97 offset:24576
    ds_read_b64_tr_b16 v[242:243], v97 offset:24832
    ds_read_b64_tr_b16 v[244:245], v97 offset:28672
    ds_read_b64_tr_b16 v[246:247], v97 offset:28928
    ds_read_b64_tr_b16 v[248:249], v97 offset:24584
    ds_read_b64_tr_b16 v[250:251], v97 offset:24840
    ds_read_b64_tr_b16 v[252:253], v97 offset:28680
    ds_read_b64_tr_b16 v[254:255], v97 offset:28936
    s_waitcnt lgkmcnt(0)
    s_barrier
    s_mov_b32 s65, s64
    s_mov_b32 s66, 0
    s_lshl_b32 s3, s65, 15
    s_lshl_b32 s4, s56, 13
    s_add_u32 s3, s3, s4
    s_add_u32 m0, s66, s4
    s_nop 0
    buffer_load_dwordx4 v0, s[52:55], s3 offen offset:0 sc1 lds
    buffer_load_dwordx4 v0, s[52:55], s3 offen offset:1024 sc1 lds
    buffer_load_dwordx4 v0, s[52:55], s3 offen offset:2048 sc1 lds
    buffer_load_dwordx4 v0, s[52:55], s3 offen offset:3072 sc1 lds
    s_add_u32 m0, m0, 4096
    s_add_u32 s3, s3, 4096
    buffer_load_dwordx4 v0, s[52:55], s3 offen offset:0 sc1 lds
    buffer_load_dwordx4 v0, s[52:55], s3 offen offset:1024 sc1 lds
    buffer_load_dwordx4 v0, s[52:55], s3 offen offset:2048 sc1 lds
    buffer_load_dwordx4 v0, s[52:55], s3 offen offset:3072 sc1 lds
    v_mov_b32 v2, v0
    v_mov_b32 v3, 1
    s_mov_b32 s68, 1072693248
    s_waitcnt vmcnt(0)
.qkv12:
    s_waitcnt vmcnt(2)
    s_barrier
    s_add_u32 s67, s65, 7
    s_cmp_eq_u32 s67, 63
    s_cselect_b32 s3, 71, s67
    s_cmp_eq_u32 s67, 64
    s_cselect_b32 s67, 63, s3
    s_xor_b32 s66, s66, 0x8000
    s_lshl_b32 s3, s67, 15
    s_lshl_b32 s4, s56, 13
    s_add_u32 s3, s3, s4
    s_add_u32 m0, s66, s4
    s_nop 0
    buffer_load_dwordx4 v0, s[52:55], s3 offen offset:0 sc1 lds
    buffer_load_dwordx4 v0, s[52:55], s3 offen offset:1024 sc1 lds
    buffer_load_dwordx4 v0, s[52:55], s3 offen offset:2048 sc1 lds
    buffer_load_dwordx4 v0, s[52:55], s3 offen offset:3072 sc1 lds
    s_add_u32 m0, m0, 4096
    s_add_u32 s3, s3, 4096
    buffer_load_dwordx4 v0, s[52:55], s3 offen offset:0 sc1 lds
    buffer_load_dwordx4 v0, s[52:55], s3 offen offset:1024 sc1 lds
    buffer_load_dwordx4 v0, s[52:55], s3 offen offset:2048 sc1 lds
    buffer_load_dwordx4 v0, s[52:55], s3 offen offset:3072 sc1 lds
    ds_read_b128 v[16:19], v2 offset:0
    ds_read_b128 v[20:23], v2 offset:1024
    ds_read_b128 v[24:27], v2 offset:2048
    ds_read_b128 v[28:31], v2 offset:3072
    ds_read_b128 v[32:35], v2 offset:4096
    ds_read_b128 v[36:39], v2 offset:5120
    ds_read_b128 v[40:43], v2 offset:6144
    ds_read_b128 v[44:47], v2 offset:7168
    s_waitcnt lgkmcnt(6)
    v_mfma_f32_16x16x32_bf16 v[48:51], v[128:131], v[16:19], 0
    v_mfma_f32_16x16x32_bf16 v[52:55], v[128:131], v[20:23], 0
    v_mfma_f32_16x16x32_bf16 v[56:59], v[136:139], v[16:19], 0
    v_mfma_f32_16x16x32_bf16 v[60:63], v[136:139], v[20:23], 0
    ds_read_b128 v[16:19], v2 offset:8192
    ds_read_b128 v[20:23], v2 offset:9216
    s_waitcnt lgkmcnt(6)
    v_mfma_f32_16x16x32_bf16 v[48:51], v[132:135], v[24:27], v[48:51]
    v_mfma_f32_16x16x32_bf16 v[52:55], v[132:135], v[28:31], v[52:55]
    v_mfma_f32_16x16x32_bf16 v[56:59], v[140:143], v[24:27], v[56:59]
    v_mfma_f32_16x16x32_bf16 v[60:63], v[140:143], v[28:31], v[60:63]
    ds_read_b128 v[24:27], v2 offset:10240
    ds_read_b128 v[28:31], v2 offset:11264
    s_waitcnt lgkmcnt(6)
    v_mfma_f32_16x16x32_bf16 v[48:51], v[144:147], v[32:35], v[48:51]
    v_mfma_f32_16x16x32_bf16 v[52:55], v[144:147], v[36:39], v[52:55]
    v_mfma_f32_16x16x32_bf16 v[56:59], v[152:155], v[32:35], v[56:59]
    v_mfma_f32_16x16x32_bf16 v[60:63], v[152:155], v[36:39], v[60:63]
    ds_read_b128 v[32:35], v2 offset:12288
    ds_read_b128 v[36:39], v2 offset:13312
    s_waitcnt lgkmcnt(6)
    v_mfma_f32_16x16x32_bf16 v[48:51], v[148:151], v[40:43], v[48:51]
    v_mfma_f32_16x16x32_bf16 v[52:55], v[148:151], v[44:47], v[52:55]
    v_mfma_f32_16x16x32_bf16 v[56:59], v[156:159], v[40:43], v[56:59]
    v_mfma_f32_16x16x32_bf16 v[60:63], v[156:159], v[44:47], v[60:63]
    ds_read_b128 v[40:43], v2 offset:14336
    ds_read_b128 v[44:47], v2 offset:15360
    s_waitcnt lgkmcnt(6)
    v_mfma_f32_16x16x32_bf16 v[48:51], v[160:163], v[16:19], v[48:51]
    v_mfma_f32_16x16x32_bf16 v[52:55], v[160:163], v[20:23], v[52:55]
    v_mfma_f32_16x16x32_bf16 v[56:59], v[168:171], v[16:19], v[56:59]
    v_mfma_f32_16x16x32_bf16 v[60:63], v[168:171], v[20:23], v[60:63]
    ds_read_b128 v[16:19], v2 offset:16384
    ds_read_b128 v[20:23], v2 offset:17408
    s_waitcnt lgkmcnt(6)
    v_mfma_f32_16x16x32_bf16 v[48:51], v[164:167], v[24:27], v[48:51]
    v_mfma_f32_16x16x32_bf16 v[52:55], v[164:167], v[28:31], v[52:55]
    v_mfma_f32_16x16x32_bf16 v[56:59], v[172:175], v[24:27], v[56:59]
    v_mfma_f32_16x16x32_bf16 v[60:63], v[172:175], v[28:31], v[60:63]
    ds_read_b128 v[24:27], v2 offset:18432
    ds_read_b128 v[28:31], v2 offset:19456
    s_waitcnt lgkmcnt(6)
    v_mfma_f32_16x16x32_bf16 v[48:51], v[176:179], v[32:35], v[48:51]
    v_mfma_f32_16x16x32_bf16 v[52:55], v[176:179], v[36:39], v[52:55]
    v_mfma_f32_16x16x32_bf16 v[56:59], v[184:187], v[32:35], v[56:59]
    v_mfma_f32_16x16x32_bf16 v[60:63], v[184:187], v[36:39], v[60:63]
    ds_read_b128 v[32:35], v2 offset:20480
    ds_read_b128 v[36:39], v2 offset:21504
    s_waitcnt lgkmcnt(6)
    v_mfma_f32_16x16x32_bf16 v[48:51], v[180:183], v[40:43], v[48:51]
    v_mfma_f32_16x16x32_bf16 v[52:55], v[180:183], v[44:47], v[52:55]
    v_mfma_f32_16x16x32_bf16 v[56:59], v[188:191], v[40:43], v[56:59]
    v_mfma_f32_16x16x32_bf16 v[60:63], v[188:191], v[44:47], v[60:63]
    ds_read_b128 v[40:43], v2 offset:22528
    ds_read_b128 v[44:47], v2 offset:23552
    s_waitcnt lgkmcnt(6)
    v_mfma_f32_16x16x32_bf16 v[48:51], v[192:195], v[16:19], v[48:51]
    v_mfma_f32_16x16x32_bf16 v[52:55], v[192:195], v[20:23], v[52:55]
    v_mfma_f32_16x16x32_bf16 v[56:59], v[200:203], v[16:19], v[56:59]
    v_mfma_f32_16x16x32_bf16 v[60:63], v[200:203], v[20:23], v[60:63]
    ds_read_b128 v[16:19], v2 offset:24576
    ds_read_b128 v[20:23], v2 offset:25600
    s_waitcnt lgkmcnt(6)
    v_mfma_f32_16x16x32_bf16 v[48:51], v[196:199], v[24:27], v[48:51]
    v_mfma_f32_16x16x32_bf16 v[52:55], v[196:199], v[28:31], v[52:55]
    v_mfma_f32_16x16x32_bf16 v[56:59], v[204:207], v[24:27], v[56:59]
    v_mfma_f32_16x16x32_bf16 v[60:63], v[204:207], v[28:31], v[60:63]
    ds_read_b128 v[24:27], v2 offset:26624
    ds_read_b128 v[28:31], v2 offset:27648
    s_waitcnt lgkmcnt(6)
    v_mfma_f32_16x16x32_bf16 v[48:51], v[208:211], v[32:35], v[48:51]
    v_mfma_f32_16x16x32_bf16 v[52:55], v[208:211], v[36:39], v[52:55]
    v_mfma_f32_16x16x32_bf16 v[56:59], v[216:219], v[32:35], v[56:59]
    v_mfma_f32_16x16x32_bf16 v[60:63], v[216:219], v[36:39], v[60:63]
    ds_read_b128 v[32:35], v2 offset:28672
    ds_read_b128 v[36:39], v2 offset:29696
    s_waitcnt lgkmcnt(6)
    v_mfma_f32_16x16x32_bf16 v[48:51], v[212:215], v[40:43], v[48:51]
    v_mfma_f32_16x16x32_bf16 v[52:55], v[212:215], v[44:47], v[52:55]
    v_mfma_f32_16x16x32_bf16 v[56:59], v[220:223], v[40:43], v[56:59]
    v_mfma_f32_16x16x32_bf16 v[60:63], v[220:223], v[44:47], v[60:63]
    ds_read_b128 v[40:43], v2 offset:30720
    ds_read_b128 v[44:47], v2 offset:31744
    s_waitcnt lgkmcnt(6)
    v_mfma_f32_16x16x32_bf16 v[48:51], v[224:227], v[16:19], v[48:51]
    v_mfma_f32_16x16x32_bf16 v[52:55], v[224:227], v[20:23], v[52:55]
    v_mfma_f32_16x16x32_bf16 v[56:59], v[232:235], v[16:19], v[56:59]
    v_mfma_f32_16x16x32_bf16 v[60:63], v[232:235], v[20:23], v[60:63]
    s_waitcnt lgkmcnt(4)
    v_mfma_f32_16x16x32_bf16 v[48:51], v[228:231], v[24:27], v[48:51]
    v_mfma_f32_16x16x32_bf16 v[52:55], v[228:231], v[28:31], v[52:55]
    v_mfma_f32_16x16x32_bf16 v[56:59], v[236:239], v[24:27], v[56:59]
    v_mfma_f32_16x16x32_bf16 v[60:63], v[236:239], v[28:31], v[60:63]
    s_waitcnt lgkmcnt(2)
    v_mfma_f32_16x16x32_bf16 v[48:51], v[240:243], v[32:35], v[48:51]
    v_mfma_f32_16x16x32_bf16 v[52:55], v[240:243], v[36:39], v[52:55]
    v_mfma_f32_16x16x32_bf16 v[56:59], v[248:251], v[32:35], v[56:59]
    v_mfma_f32_16x16x32_bf16 v[60:63], v[248:251], v[36:39], v[60:63]
    s_waitcnt lgkmcnt(0)
    v_mfma_f32_16x16x32_bf16 v[48:51], v[244:247], v[40:43], v[48:51]
    v_mfma_f32_16x16x32_bf16 v[52:55], v[244:247], v[44:47], v[52:55]
    v_mfma_f32_16x16x32_bf16 v[56:59], v[252:255], v[40:43], v[56:59]
    v_mfma_f32_16x16x32_bf16 v[60:63], v[252:255], v[44:47], v[60:63]
    s_lshl_b32 s3, s63, 6
    s_add_u32 s3, s3, s65
    s_mul_i32 s3, s63, 24576
    s_mul_i32 s4, s65, 786432
    s_add_u32 s3, s3, s4
    s_lshl_b32 s4, s56, 10
    s_add_u32 s3, s3, s4
    s_add_u32 s3, s3, 2097152
    s_add_u32 s4, s3, s4
    v_cvt_pk_bf16_f32 v104, v48, v49
    v_cvt_pk_bf16_f32 v105, v50, v51
    v_cvt_pk_bf16_f32 v106, v56, v57
    v_cvt_pk_bf16_f32 v107, v58, v59
    s_add_u32 s5, s3, 16384
    buffer_store_dwordx4 v[104:107], v0, s[52:55], s5 offen sc1
    v_cvt_pk_bf16_f32 v108, v52, v53
    v_cvt_pk_bf16_f32 v109, v54, v55
    v_cvt_pk_bf16_f32 v110, v60, v61
    v_cvt_pk_bf16_f32 v111, v62, v63
    s_add_u32 s5, s3, 20480
    buffer_store_dwordx4 v[108:111], v0, s[52:55], s5 offen sc1
    v_xor_b32 v2, 0x8000, v2
    s_mov_b32 s65, s67
    s_cmp_lt_u32 s65, 64
    s_cbranch_scc1 .qkv12
    s_waitcnt vmcnt(0)
    s_barrier
    s_lshr_b32 s70, s62, 4
    v_bfe_u32 v8, v0, 6, 1
    v_lshlrev_b32 v4, 0, v8
    v_bfe_u32 v8, v0, 7, 1
    v_lshl_or_b32 v4, v8, 1, v4
    v_bfe_u32 v8, v0, 8, 1
    v_lshl_or_b32 v4, v8, 2, v4
    v_bfe_u32 v8, v0, 9, 1
    v_lshl_or_b32 v4, v8, 3, v4
    s_mov_b32 s3, 3584
    v_mul_lo_u32 v4, v4, s3
    v_and_b32 v8, 0x30, v0
    s_lshl_b32 s3, s56, 6
    v_add3_u32 v4, v4, v8, s3
    v_add_u32 v5, 56320, v4
    v_add_u32 v6, 112640, v4
    v_add_u32 v7, 168960, v4
    v_bfe_u32 v8, v0, 6, 1
    v_lshlrev_b32 v12, 0, v8
    v_bfe_u32 v8, v0, 7, 1
    v_lshl_or_b32 v12, v8, 1, v12
    v_bfe_u32 v8, v0, 8, 1
    v_lshl_or_b32 v12, v8, 2, v12
    v_bfe_u32 v8, v0, 9, 1
    v_lshl_or_b32 v12, v8, 3, v12
    s_mov_b32 s3, 1024
    v_mul_lo_u32 v12, v12, s3
    v_and_b32 v8, 0x30, v0
    s_lshl_b32 s3, s56, 8
    v_add3_u32 v12, v12, v8, s3
    v_add_u32 v13, 15360, v12
    v_add_u32 v14, 30720, v12
    v_add_u32 v15, 46080, v12
    s_lshl_b32 s71, s70, 8
    s_lshl_b32 s67, s70, 17
    s_add_u32 m0, s61, 0
    s_add_u32 s3, s71, 0
    buffer_load_dwordx4 v4, s[32:35], s3 offen offset:0 lds
    buffer_load_dwordx4 v5, s[32:35], s3 offen offset:1024 lds
    buffer_load_dwordx4 v6, s[32:35], s3 offen offset:2048 lds
    buffer_load_dwordx4 v7, s[32:35], s3 offen offset:3072 lds
    s_add_u32 m0, s61, 4096
    s_add_u32 s3, s71, 229376
    buffer_load_dwordx4 v4, s[32:35], s3 offen offset:0 lds
    buffer_load_dwordx4 v5, s[32:35], s3 offen offset:1024 lds
    buffer_load_dwordx4 v6, s[32:35], s3 offen offset:2048 lds
    buffer_load_dwordx4 v7, s[32:35], s3 offen offset:3072 lds
    s_add_u32 m0, s61, 8192
    s_add_u32 s3, s71, 458752
    buffer_load_dwordx4 v4, s[32:35], s3 offen offset:0 lds
    buffer_load_dwordx4 v5, s[32:35], s3 offen offset:1024 lds
    buffer_load_dwordx4 v6, s[32:35], s3 offen offset:2048 lds
    buffer_load_dwordx4 v7, s[32:35], s3 offen offset:3072 lds
    s_add_u32 m0, s61, 12288
    s_add_u32 s3, s71, 688128
    buffer_load_dwordx4 v4, s[32:35], s3 offen offset:0 lds
    buffer_load_dwordx4 v5, s[32:35], s3 offen offset:1024 lds
    buffer_load_dwordx4 v6, s[32:35], s3 offen offset:2048 lds
    buffer_load_dwordx4 v7, s[32:35], s3 offen offset:3072 lds
    s_add_u32 m0, s61, 16384
    s_add_u32 s3, s71, 917504
    buffer_load_dwordx4 v4, s[32:35], s3 offen offset:0 lds
    buffer_load_dwordx4 v5, s[32:35], s3 offen offset:1024 lds
    buffer_load_dwordx4 v6, s[32:35], s3 offen offset:2048 lds
    buffer_load_dwordx4 v7, s[32:35], s3 offen offset:3072 lds
    s_add_u32 m0, s61, 20480
    s_add_u32 s3, s71, 1146880
    buffer_load_dwordx4 v4, s[32:35], s3 offen offset:0 lds
    buffer_load_dwordx4 v5, s[32:35], s3 offen offset:1024 lds
    buffer_load_dwordx4 v6, s[32:35], s3 offen offset:2048 lds
    buffer_load_dwordx4 v7, s[32:35], s3 offen offset:3072 lds
    s_add_u32 m0, s61, 24576
    s_add_u32 s3, s71, 1376256
    buffer_load_dwordx4 v4, s[32:35], s3 offen offset:0 lds
    buffer_load_dwordx4 v5, s[32:35], s3 offen offset:1024 lds
    buffer_load_dwordx4 v6, s[32:35], s3 offen offset:2048 lds
    buffer_load_dwordx4 v7, s[32:35], s3 offen offset:3072 lds
    s_add_u32 m0, s61, 28672
    s_add_u32 s3, s71, 1605632
    buffer_load_dwordx4 v4, s[32:35], s3 offen offset:0 lds
    buffer_load_dwordx4 v5, s[32:35], s3 offen offset:1024 lds
    buffer_load_dwordx4 v6, s[32:35], s3 offen offset:2048 lds
    buffer_load_dwordx4 v7, s[32:35], s3 offen offset:3072 lds
    s_waitcnt vmcnt(28)
    ds_read_b64_tr_b16 v[128:129], v1 offset:0
    ds_read_b64_tr_b16 v[130:131], v1 offset:256
    ds_read_b64_tr_b16 v[132:133], v1 offset:2048
    ds_read_b64_tr_b16 v[134:135], v1 offset:2304
    ds_read_b64_tr_b16 v[136:137], v1 offset:8
    ds_read_b64_tr_b16 v[138:139], v1 offset:264
    ds_read_b64_tr_b16 v[140:141], v1 offset:2056
    ds_read_b64_tr_b16 v[142:143], v1 offset:2312
    s_waitcnt lgkmcnt(0)
    s_add_u32 m0, s61, 0
    s_add_u32 s3, s71, 0
    buffer_load_dwordx4 v4, s[36:39], s3 offen offset:0 lds
    buffer_load_dwordx4 v5, s[36:39], s3 offen offset:1024 lds
    buffer_load_dwordx4 v6, s[36:39], s3 offen offset:2048 lds
    buffer_load_dwordx4 v7, s[36:39], s3 offen offset:3072 lds
    s_waitcnt vmcnt(28)
    ds_read_b64_tr_b16 v[144:145], v1 offset:4096
    ds_read_b64_tr_b16 v[146:147], v1 offset:4352
    ds_read_b64_tr_b16 v[148:149], v1 offset:6144
    ds_read_b64_tr_b16 v[150:151], v1 offset:6400
    ds_read_b64_tr_b16 v[152:153], v1 offset:4104
    ds_read_b64_tr_b16 v[154:155], v1 offset:4360
    ds_read_b64_tr_b16 v[156:157], v1 offset:6152
    ds_read_b64_tr_b16 v[158:159], v1 offset:6408
    s_waitcnt lgkmcnt(0)
    s_add_u32 m0, s61, 4096
    s_add_u32 s3, s71, 229376
    buffer_load_dwordx4 v4, s[36:39], s3 offen offset:0 lds
    buffer_load_dwordx4 v5, s[36:39], s3 offen offset:1024 lds
    buffer_load_dwordx4 v6, s[36:39], s3 offen offset:2048 lds
    buffer_load_dwordx4 v7, s[36:39], s3 offen offset:3072 lds
    s_waitcnt vmcnt(28)
    ds_read_b64_tr_b16 v[160:161], v1 offset:8192
    ds_read_b64_tr_b16 v[162:163], v1 offset:8448
    ds_read_b64_tr_b16 v[164:165], v1 offset:10240
    ds_read_b64_tr_b16 v[166:167], v1 offset:10496
    ds_read_b64_tr_b16 v[168:169], v1 offset:8200
    ds_read_b64_tr_b16 v[170:171], v1 offset:8456
    ds_read_b64_tr_b16 v[172:173], v1 offset:10248
    ds_read_b64_tr_b16 v[174:175], v1 offset:10504
    s_waitcnt lgkmcnt(0)
    s_add_u32 m0, s61, 8192
    s_add_u32 s3, s71, 458752
    buffer_load_dwordx4 v4, s[36:39], s3 offen offset:0 lds
    buffer_load_dwordx4 v5, s[36:39], s3 offen offset:1024 lds
    buffer_load_dwordx4 v6, s[36:39], s3 offen offset:2048 lds
    buffer_load_dwordx4 v7, s[36:39], s3 offen offset:3072 lds
    s_waitcnt vmcnt(28)
    ds_read_b64_tr_b16 v[176:177], v1 offset:12288
    ds_read_b64_tr_b16 v[178:179], v1 offset:12544
    ds_read_b64_tr_b16 v[180:181], v1 offset:14336
    ds_read_b64_tr_b16 v[182:183], v1 offset:14592
    ds_read_b64_tr_b16 v[184:185], v1 offset:12296
    ds_read_b64_tr_b16 v[186:187], v1 offset:12552
    ds_read_b64_tr_b16 v[188:189], v1 offset:14344
    ds_read_b64_tr_b16 v[190:191], v1 offset:14600
    s_waitcnt lgkmcnt(0)
    s_add_u32 m0, s61, 12288
    s_add_u32 s3, s71, 688128
    buffer_load_dwordx4 v4, s[36:39], s3 offen offset:0 lds
    buffer_load_dwordx4 v5, s[36:39], s3 offen offset:1024 lds
    buffer_load_dwordx4 v6, s[36:39], s3 offen offset:2048 lds
    buffer_load_dwordx4 v7, s[36:39], s3 offen offset:3072 lds
    s_waitcnt vmcnt(28)
    ds_read_b64_tr_b16 v[192:193], v1 offset:16384
    ds_read_b64_tr_b16 v[194:195], v1 offset:16640
    ds_read_b64_tr_b16 v[196:197], v1 offset:18432
    ds_read_b64_tr_b16 v[198:199], v1 offset:18688
    ds_read_b64_tr_b16 v[200:201], v1 offset:16392
    ds_read_b64_tr_b16 v[202:203], v1 offset:16648
    ds_read_b64_tr_b16 v[204:205], v1 offset:18440
    ds_read_b64_tr_b16 v[206:207], v1 offset:18696
    s_waitcnt lgkmcnt(0)
    s_add_u32 m0, s61, 16384
    s_add_u32 s3, s71, 917504
    buffer_load_dwordx4 v4, s[36:39], s3 offen offset:0 lds
    buffer_load_dwordx4 v5, s[36:39], s3 offen offset:1024 lds
    buffer_load_dwordx4 v6, s[36:39], s3 offen offset:2048 lds
    buffer_load_dwordx4 v7, s[36:39], s3 offen offset:3072 lds
    s_waitcnt vmcnt(28)
    ds_read_b64_tr_b16 v[208:209], v1 offset:20480
    ds_read_b64_tr_b16 v[210:211], v1 offset:20736
    ds_read_b64_tr_b16 v[212:213], v1 offset:22528
    ds_read_b64_tr_b16 v[214:215], v1 offset:22784
    ds_read_b64_tr_b16 v[216:217], v1 offset:20488
    ds_read_b64_tr_b16 v[218:219], v1 offset:20744
    ds_read_b64_tr_b16 v[220:221], v1 offset:22536
    ds_read_b64_tr_b16 v[222:223], v1 offset:22792
    s_waitcnt lgkmcnt(0)
    s_add_u32 m0, s61, 20480
    s_add_u32 s3, s71, 1146880
    buffer_load_dwordx4 v4, s[36:39], s3 offen offset:0 lds
    buffer_load_dwordx4 v5, s[36:39], s3 offen offset:1024 lds
    buffer_load_dwordx4 v6, s[36:39], s3 offen offset:2048 lds
    buffer_load_dwordx4 v7, s[36:39], s3 offen offset:3072 lds
    s_waitcnt vmcnt(28)
    ds_read_b64_tr_b16 v[224:225], v1 offset:24576
    ds_read_b64_tr_b16 v[226:227], v1 offset:24832
    ds_read_b64_tr_b16 v[228:229], v1 offset:26624
    ds_read_b64_tr_b16 v[230:231], v1 offset:26880
    ds_read_b64_tr_b16 v[232:233], v1 offset:24584
    ds_read_b64_tr_b16 v[234:235], v1 offset:24840
    ds_read_b64_tr_b16 v[236:237], v1 offset:26632
    ds_read_b64_tr_b16 v[238:239], v1 offset:26888
    s_waitcnt lgkmcnt(0)
    s_add_u32 m0, s61, 24576
    s_add_u32 s3, s71, 1376256
    buffer_load_dwordx4 v4, s[36:39], s3 offen offset:0 lds
    buffer_load_dwordx4 v5, s[36:39], s3 offen offset:1024 lds
    buffer_load_dwordx4 v6, s[36:39], s3 offen offset:2048 lds
    buffer_load_dwordx4 v7, s[36:39], s3 offen offset:3072 lds
    s_waitcnt vmcnt(28)
    ds_read_b64_tr_b16 v[240:241], v1 offset:28672
    ds_read_b64_tr_b16 v[242:243], v1 offset:28928
    ds_read_b64_tr_b16 v[244:245], v1 offset:30720
    ds_read_b64_tr_b16 v[246:247], v1 offset:30976
    ds_read_b64_tr_b16 v[248:249], v1 offset:28680
    ds_read_b64_tr_b16 v[250:251], v1 offset:28936
    ds_read_b64_tr_b16 v[252:253], v1 offset:30728
    ds_read_b64_tr_b16 v[254:255], v1 offset:30984
    s_waitcnt lgkmcnt(0)
    s_add_u32 m0, s61, 28672
    s_add_u32 s3, s71, 1605632
    buffer_load_dwordx4 v4, s[36:39], s3 offen offset:0 lds
    buffer_load_dwordx4 v5, s[36:39], s3 offen offset:1024 lds
    buffer_load_dwordx4 v6, s[36:39], s3 offen offset:2048 lds
    buffer_load_dwordx4 v7, s[36:39], s3 offen offset:3072 lds
    s_waitcnt vmcnt(28)
    ds_read_b64_tr_b16 a[0:1], v1 offset:0
    ds_read_b64_tr_b16 a[2:3], v1 offset:256
    ds_read_b64_tr_b16 a[4:5], v1 offset:2048
    ds_read_b64_tr_b16 a[6:7], v1 offset:2304
    ds_read_b64_tr_b16 a[8:9], v1 offset:8
    ds_read_b64_tr_b16 a[10:11], v1 offset:264
    ds_read_b64_tr_b16 a[12:13], v1 offset:2056
    ds_read_b64_tr_b16 a[14:15], v1 offset:2312
    s_waitcnt lgkmcnt(0)
    s_add_u32 m0, s61, 0
    s_add_u32 s3, s67, 0
    buffer_load_dwordx4 v12, s[40:43], s3 offen offset:0 lds
    buffer_load_dwordx4 v13, s[40:43], s3 offen offset:1024 lds
    buffer_load_dwordx4 v14, s[40:43], s3 offen offset:2048 lds
    buffer_load_dwordx4 v15, s[40:43], s3 offen offset:3072 lds
    s_waitcnt vmcnt(28)
    ds_read_b64_tr_b16 a[16:17], v1 offset:4096
    ds_read_b64_tr_b16 a[18:19], v1 offset:4352
    ds_read_b64_tr_b16 a[20:21], v1 offset:6144
    ds_read_b64_tr_b16 a[22:23], v1 offset:6400
    ds_read_b64_tr_b16 a[24:25], v1 offset:4104
    ds_read_b64_tr_b16 a[26:27], v1 offset:4360
    ds_read_b64_tr_b16 a[28:29], v1 offset:6152
    ds_read_b64_tr_b16 a[30:31], v1 offset:6408
    s_waitcnt lgkmcnt(0)
    s_add_u32 m0, s61, 4096
    s_add_u32 s3, s67, 65536
    buffer_load_dwordx4 v12, s[40:43], s3 offen offset:0 lds
    buffer_load_dwordx4 v13, s[40:43], s3 offen offset:1024 lds
    buffer_load_dwordx4 v14, s[40:43], s3 offen offset:2048 lds
    buffer_load_dwordx4 v15, s[40:43], s3 offen offset:3072 lds
    s_waitcnt vmcnt(28)
    ds_read_b64_tr_b16 a[32:33], v1 offset:8192
    ds_read_b64_tr_b16 a[34:35], v1 offset:8448
    ds_read_b64_tr_b16 a[36:37], v1 offset:10240
    ds_read_b64_tr_b16 a[38:39], v1 offset:10496
    ds_read_b64_tr_b16 a[40:41], v1 offset:8200
    ds_read_b64_tr_b16 a[42:43], v1 offset:8456
    ds_read_b64_tr_b16 a[44:45], v1 offset:10248
    ds_read_b64_tr_b16 a[46:47], v1 offset:10504
    s_waitcnt lgkmcnt(0)
    s_add_u32 m0, s61, 8192
    s_add_u32 s3, s67, 64
    buffer_load_dwordx4 v12, s[40:43], s3 offen offset:0 lds
    buffer_load_dwordx4 v13, s[40:43], s3 offen offset:1024 lds
    buffer_load_dwordx4 v14, s[40:43], s3 offen offset:2048 lds
    buffer_load_dwordx4 v15, s[40:43], s3 offen offset:3072 lds
    s_waitcnt vmcnt(28)
    ds_read_b64_tr_b16 a[48:49], v1 offset:12288
    ds_read_b64_tr_b16 a[50:51], v1 offset:12544
    ds_read_b64_tr_b16 a[52:53], v1 offset:14336
    ds_read_b64_tr_b16 a[54:55], v1 offset:14592
    ds_read_b64_tr_b16 a[56:57], v1 offset:12296
    ds_read_b64_tr_b16 a[58:59], v1 offset:12552
    ds_read_b64_tr_b16 a[60:61], v1 offset:14344
    ds_read_b64_tr_b16 a[62:63], v1 offset:14600
    s_waitcnt lgkmcnt(0)
    s_add_u32 m0, s61, 12288
    s_add_u32 s3, s67, 65600
    buffer_load_dwordx4 v12, s[40:43], s3 offen offset:0 lds
    buffer_load_dwordx4 v13, s[40:43], s3 offen offset:1024 lds
    buffer_load_dwordx4 v14, s[40:43], s3 offen offset:2048 lds
    buffer_load_dwordx4 v15, s[40:43], s3 offen offset:3072 lds
    s_waitcnt vmcnt(28)
    ds_read_b64_tr_b16 a[64:65], v1 offset:16384
    ds_read_b64_tr_b16 a[66:67], v1 offset:16640
    ds_read_b64_tr_b16 a[68:69], v1 offset:18432
    ds_read_b64_tr_b16 a[70:71], v1 offset:18688
    ds_read_b64_tr_b16 a[72:73], v1 offset:16392
    ds_read_b64_tr_b16 a[74:75], v1 offset:16648
    ds_read_b64_tr_b16 a[76:77], v1 offset:18440
    ds_read_b64_tr_b16 a[78:79], v1 offset:18696
    s_waitcnt lgkmcnt(0)
    s_add_u32 m0, s61, 16384
    s_add_u32 s3, s67, 128
    buffer_load_dwordx4 v12, s[40:43], s3 offen offset:0 lds
    buffer_load_dwordx4 v13, s[40:43], s3 offen offset:1024 lds
    buffer_load_dwordx4 v14, s[40:43], s3 offen offset:2048 lds
    buffer_load_dwordx4 v15, s[40:43], s3 offen offset:3072 lds
    s_waitcnt vmcnt(28)
    ds_read_b64_tr_b16 a[80:81], v1 offset:20480
    ds_read_b64_tr_b16 a[82:83], v1 offset:20736
    ds_read_b64_tr_b16 a[84:85], v1 offset:22528
    ds_read_b64_tr_b16 a[86:87], v1 offset:22784
    ds_read_b64_tr_b16 a[88:89], v1 offset:20488
    ds_read_b64_tr_b16 a[90:91], v1 offset:20744
    ds_read_b64_tr_b16 a[92:93], v1 offset:22536
    ds_read_b64_tr_b16 a[94:95], v1 offset:22792
    s_waitcnt lgkmcnt(0)
    s_add_u32 m0, s61, 20480
    s_add_u32 s3, s67, 65664
    buffer_load_dwordx4 v12, s[40:43], s3 offen offset:0 lds
    buffer_load_dwordx4 v13, s[40:43], s3 offen offset:1024 lds
    buffer_load_dwordx4 v14, s[40:43], s3 offen offset:2048 lds
    buffer_load_dwordx4 v15, s[40:43], s3 offen offset:3072 lds
    s_waitcnt vmcnt(28)
    ds_read_b64_tr_b16 a[96:97], v1 offset:24576
    ds_read_b64_tr_b16 a[98:99], v1 offset:24832
    ds_read_b64_tr_b16 a[100:101], v1 offset:26624
    ds_read_b64_tr_b16 a[102:103], v1 offset:26880
    ds_read_b64_tr_b16 a[104:105], v1 offset:24584
    ds_read_b64_tr_b16 a[106:107], v1 offset:24840
    ds_read_b64_tr_b16 a[108:109], v1 offset:26632
    ds_read_b64_tr_b16 a[110:111], v1 offset:26888
    s_waitcnt lgkmcnt(0)
    s_add_u32 m0, s61, 24576
    s_add_u32 s3, s67, 192
    buffer_load_dwordx4 v12, s[40:43], s3 offen offset:0 lds
    buffer_load_dwordx4 v13, s[40:43], s3 offen offset:1024 lds
    buffer_load_dwordx4 v14, s[40:43], s3 offen offset:2048 lds
    buffer_load_dwordx4 v15, s[40:43], s3 offen offset:3072 lds
    s_waitcnt vmcnt(28)
    ds_read_b64_tr_b16 a[112:113], v1 offset:28672
    ds_read_b64_tr_b16 a[114:115], v1 offset:28928
    ds_read_b64_tr_b16 a[116:117], v1 offset:30720
    ds_read_b64_tr_b16 a[118:119], v1 offset:30976
    ds_read_b64_tr_b16 a[120:121], v1 offset:28680
    ds_read_b64_tr_b16 a[122:123], v1 offset:28936
    ds_read_b64_tr_b16 a[124:125], v1 offset:30728
    ds_read_b64_tr_b16 a[126:127], v1 offset:30984
    s_waitcnt lgkmcnt(0)
    s_add_u32 m0, s61, 28672
    s_add_u32 s3, s67, 65728
    buffer_load_dwordx4 v12, s[40:43], s3 offen offset:0 lds
    buffer_load_dwordx4 v13, s[40:43], s3 offen offset:1024 lds
    buffer_load_dwordx4 v14, s[40:43], s3 offen offset:2048 lds
    buffer_load_dwordx4 v15, s[40:43], s3 offen offset:3072 lds
    s_waitcnt vmcnt(28)
    ds_read_b64_tr_b16 a[128:129], v1 offset:0
    ds_read_b64_tr_b16 a[130:131], v1 offset:256
    ds_read_b64_tr_b16 a[132:133], v1 offset:2048
    ds_read_b64_tr_b16 a[134:135], v1 offset:2304
    ds_read_b64_tr_b16 a[136:137], v1 offset:8
    ds_read_b64_tr_b16 a[138:139], v1 offset:264
    ds_read_b64_tr_b16 a[140:141], v1 offset:2056
    ds_read_b64_tr_b16 a[142:143], v1 offset:2312
    s_waitcnt vmcnt(24)
    ds_read_b64_tr_b16 a[144:145], v1 offset:4096
    ds_read_b64_tr_b16 a[146:147], v1 offset:4352
    ds_read_b64_tr_b16 a[148:149], v1 offset:6144
    ds_read_b64_tr_b16 a[150:151], v1 offset:6400
    ds_read_b64_tr_b16 a[152:153], v1 offset:4104
    ds_read_b64_tr_b16 a[154:155], v1 offset:4360
    ds_read_b64_tr_b16 a[156:157], v1 offset:6152
    ds_read_b64_tr_b16 a[158:159], v1 offset:6408
    s_waitcnt vmcnt(20)
    ds_read_b64_tr_b16 a[160:161], v1 offset:8192
    ds_read_b64_tr_b16 a[162:163], v1 offset:8448
    ds_read_b64_tr_b16 a[164:165], v1 offset:10240
    ds_read_b64_tr_b16 a[166:167], v1 offset:10496
    ds_read_b64_tr_b16 a[168:169], v1 offset:8200
    ds_read_b64_tr_b16 a[170:171], v1 offset:8456
    ds_read_b64_tr_b16 a[172:173], v1 offset:10248
    ds_read_b64_tr_b16 a[174:175], v1 offset:10504
    s_waitcnt vmcnt(16)
    ds_read_b64_tr_b16 a[176:177], v1 offset:12288
    ds_read_b64_tr_b16 a[178:179], v1 offset:12544
    ds_read_b64_tr_b16 a[180:181], v1 offset:14336
    ds_read_b64_tr_b16 a[182:183], v1 offset:14592
    ds_read_b64_tr_b16 a[184:185], v1 offset:12296
    ds_read_b64_tr_b16 a[186:187], v1 offset:12552
    ds_read_b64_tr_b16 a[188:189], v1 offset:14344
    ds_read_b64_tr_b16 a[190:191], v1 offset:14600
    s_waitcnt vmcnt(12)
    ds_read_b64_tr_b16 a[192:193], v1 offset:16384
    ds_read_b64_tr_b16 a[194:195], v1 offset:16640
    ds_read_b64_tr_b16 a[196:197], v1 offset:18432
    ds_read_b64_tr_b16 a[198:199], v1 offset:18688
    ds_read_b64_tr_b16 a[200:201], v1 offset:16392
    ds_read_b64_tr_b16 a[202:203], v1 offset:16648
    ds_read_b64_tr_b16 a[204:205], v1 offset:18440
    ds_read_b64_tr_b16 a[206:207], v1 offset:18696
    s_waitcnt vmcnt(8)
    ds_read_b64_tr_b16 a[208:209], v1 offset:20480
    ds_read_b64_tr_b16 a[210:211], v1 offset:20736
    ds_read_b64_tr_b16 a[212:213], v1 offset:22528
    ds_read_b64_tr_b16 a[214:215], v1 offset:22784
    ds_read_b64_tr_b16 a[216:217], v1 offset:20488
    ds_read_b64_tr_b16 a[218:219], v1 offset:20744
    ds_read_b64_tr_b16 a[220:221], v1 offset:22536
    ds_read_b64_tr_b16 a[222:223], v1 offset:22792
    s_waitcnt vmcnt(4)
    ds_read_b64_tr_b16 a[224:225], v1 offset:24576
    ds_read_b64_tr_b16 a[226:227], v1 offset:24832
    ds_read_b64_tr_b16 a[228:229], v1 offset:26624
    ds_read_b64_tr_b16 a[230:231], v1 offset:26880
    ds_read_b64_tr_b16 a[232:233], v1 offset:24584
    ds_read_b64_tr_b16 a[234:235], v1 offset:24840
    ds_read_b64_tr_b16 a[236:237], v1 offset:26632
    ds_read_b64_tr_b16 a[238:239], v1 offset:26888
    s_waitcnt vmcnt(0)
    ds_read_b64_tr_b16 a[240:241], v1 offset:28672
    ds_read_b64_tr_b16 a[242:243], v1 offset:28928
    ds_read_b64_tr_b16 a[244:245], v1 offset:30720
    ds_read_b64_tr_b16 a[246:247], v1 offset:30976
    ds_read_b64_tr_b16 a[248:249], v1 offset:28680
    ds_read_b64_tr_b16 a[250:251], v1 offset:28936
    ds_read_b64_tr_b16 a[252:253], v1 offset:30728
    ds_read_b64_tr_b16 a[254:255], v1 offset:30984
    s_waitcnt lgkmcnt(0)
    s_barrier
    s_and_b32 s65, s62, 15
    s_lshl_b32 s65, s65, 2
    s_mov_b32 s66, 0
    s_lshl_b32 s3, s65, 15
    s_lshl_b32 s4, s56, 13
    s_add_u32 s3, s3, s4
    s_add_u32 m0, s66, s4
    s_nop 0
    buffer_load_dwordx4 v0, s[52:55], s3 offen offset:0 sc1 lds
    buffer_load_dwordx4 v0, s[52:55], s3 offen offset:1024 sc1 lds
    buffer_load_dwordx4 v0, s[52:55], s3 offen offset:2048 sc1 lds
    buffer_load_dwordx4 v0, s[52:55], s3 offen offset:3072 sc1 lds
    s_add_u32 m0, m0, 4096
    s_add_u32 s3, s3, 4096
    buffer_load_dwordx4 v0, s[52:55], s3 offen offset:0 sc1 lds
    buffer_load_dwordx4 v0, s[52:55], s3 offen offset:1024 sc1 lds
    buffer_load_dwordx4 v0, s[52:55], s3 offen offset:2048 sc1 lds
    buffer_load_dwordx4 v0, s[52:55], s3 offen offset:3072 sc1 lds
    v_mov_b32 v2, v0
    v_add_u32 v4, 65536, v0
    s_lshl_b32 s3, s56, 10
    v_add_u32 v5, s3, v4
    s_mov_b32 s68, 1072693248
    s_waitcnt vmcnt(0)
.ffn13:
    s_waitcnt vmcnt(9)
    s_barrier
    s_add_u32 s67, s65, 1
    s_xor_b32 s66, s66, 0x8000
    s_lshl_b32 s3, s67, 15
    s_lshl_b32 s4, s56, 13
    s_add_u32 s3, s3, s4
    s_add_u32 m0, s66, s4
    s_nop 0
    buffer_load_dwordx4 v0, s[52:55], s3 offen offset:0 sc1 lds
    buffer_load_dwordx4 v0, s[52:55], s3 offen offset:1024 sc1 lds
    buffer_load_dwordx4 v0, s[52:55], s3 offen offset:2048 sc1 lds
    buffer_load_dwordx4 v0, s[52:55], s3 offen offset:3072 sc1 lds
    s_add_u32 m0, m0, 4096
    s_add_u32 s3, s3, 4096
    buffer_load_dwordx4 v0, s[52:55], s3 offen offset:0 sc1 lds
    buffer_load_dwordx4 v0, s[52:55], s3 offen offset:1024 sc1 lds
    buffer_load_dwordx4 v0, s[52:55], s3 offen offset:2048 sc1 lds
    buffer_load_dwordx4 v0, s[52:55], s3 offen offset:3072 sc1 lds
    ds_read_b128 v[16:19], v2 offset:0
    ds_read_b128 v[20:23], v2 offset:1024
    ds_read_b128 v[24:27], v2 offset:2048
    ds_read_b128 v[28:31], v2 offset:3072
    ds_read_b128 v[32:35], v2 offset:4096
    ds_read_b128 v[36:39], v2 offset:5120
    ds_read_b128 v[40:43], v2 offset:6144
    ds_read_b128 v[44:47], v2 offset:7168
    s_waitcnt lgkmcnt(6)
    v_mfma_f32_16x16x32_bf16 v[48:51], v[128:131], v[16:19], 0
    v_mfma_f32_16x16x32_bf16 v[52:55], v[128:131], v[20:23], 0
    v_mfma_f32_16x16x32_bf16 v[56:59], v[136:139], v[16:19], 0
    v_mfma_f32_16x16x32_bf16 v[60:63], v[136:139], v[20:23], 0
    v_mfma_f32_16x16x32_bf16 v[64:67], a[0:3], v[16:19], 0
    v_mfma_f32_16x16x32_bf16 v[68:71], a[0:3], v[20:23], 0
    v_mfma_f32_16x16x32_bf16 v[72:75], a[8:11], v[16:19], 0
    v_mfma_f32_16x16x32_bf16 v[76:79], a[8:11], v[20:23], 0
    ds_read_b128 v[16:19], v2 offset:8192
    ds_read_b128 v[20:23], v2 offset:9216
    s_waitcnt lgkmcnt(6)
    v_mfma_f32_16x16x32_bf16 v[48:51], v[132:135], v[24:27], v[48:51]
    v_mfma_f32_16x16x32_bf16 v[52:55], v[132:135], v[28:31], v[52:55]
    v_mfma_f32_16x16x32_bf16 v[56:59], v[140:143], v[24:27], v[56:59]
    v_mfma_f32_16x16x32_bf16 v[60:63], v[140:143], v[28:31], v[60:63]
    v_mfma_f32_16x16x32_bf16 v[64:67], a[4:7], v[24:27], v[64:67]
    v_mfma_f32_16x16x32_bf16 v[68:71], a[4:7], v[28:31], v[68:71]
    v_mfma_f32_16x16x32_bf16 v[72:75], a[12:15], v[24:27], v[72:75]
    v_mfma_f32_16x16x32_bf16 v[76:79], a[12:15], v[28:31], v[76:79]
    ds_read_b128 v[24:27], v2 offset:10240
    ds_read_b128 v[28:31], v2 offset:11264
    s_waitcnt lgkmcnt(6)
    v_mfma_f32_16x16x32_bf16 v[48:51], v[144:147], v[32:35], v[48:51]
    v_mfma_f32_16x16x32_bf16 v[52:55], v[144:147], v[36:39], v[52:55]
    v_mfma_f32_16x16x32_bf16 v[56:59], v[152:155], v[32:35], v[56:59]
    v_mfma_f32_16x16x32_bf16 v[60:63], v[152:155], v[36:39], v[60:63]
    v_mfma_f32_16x16x32_bf16 v[64:67], a[16:19], v[32:35], v[64:67]
    v_mfma_f32_16x16x32_bf16 v[68:71], a[16:19], v[36:39], v[68:71]
    v_mfma_f32_16x16x32_bf16 v[72:75], a[24:27], v[32:35], v[72:75]
    v_mfma_f32_16x16x32_bf16 v[76:79], a[24:27], v[36:39], v[76:79]
    ds_read_b128 v[32:35], v2 offset:12288
    ds_read_b128 v[36:39], v2 offset:13312
    s_waitcnt lgkmcnt(6)
    v_mfma_f32_16x16x32_bf16 v[48:51], v[148:151], v[40:43], v[48:51]
    v_mfma_f32_16x16x32_bf16 v[52:55], v[148:151], v[44:47], v[52:55]
    v_mfma_f32_16x16x32_bf16 v[56:59], v[156:159], v[40:43], v[56:59]
    v_mfma_f32_16x16x32_bf16 v[60:63], v[156:159], v[44:47], v[60:63]
    v_mfma_f32_16x16x32_bf16 v[64:67], a[20:23], v[40:43], v[64:67]
    v_mfma_f32_16x16x32_bf16 v[68:71], a[20:23], v[44:47], v[68:71]
    v_mfma_f32_16x16x32_bf16 v[72:75], a[28:31], v[40:43], v[72:75]
    v_mfma_f32_16x16x32_bf16 v[76:79], a[28:31], v[44:47], v[76:79]
    ds_read_b128 v[40:43], v2 offset:14336
    ds_read_b128 v[44:47], v2 offset:15360
    s_waitcnt lgkmcnt(6)
    v_mfma_f32_16x16x32_bf16 v[48:51], v[160:163], v[16:19], v[48:51]
    v_mfma_f32_16x16x32_bf16 v[52:55], v[160:163], v[20:23], v[52:55]
    v_mfma_f32_16x16x32_bf16 v[56:59], v[168:171], v[16:19], v[56:59]
    v_mfma_f32_16x16x32_bf16 v[60:63], v[168:171], v[20:23], v[60:63]
    v_mfma_f32_16x16x32_bf16 v[64:67], a[32:35], v[16:19], v[64:67]
    v_mfma_f32_16x16x32_bf16 v[68:71], a[32:35], v[20:23], v[68:71]
    v_mfma_f32_16x16x32_bf16 v[72:75], a[40:43], v[16:19], v[72:75]
    v_mfma_f32_16x16x32_bf16 v[76:79], a[40:43], v[20:23], v[76:79]
    ds_read_b128 v[16:19], v2 offset:16384
    ds_read_b128 v[20:23], v2 offset:17408
    s_waitcnt lgkmcnt(6)
    v_mfma_f32_16x16x32_bf16 v[48:51], v[164:167], v[24:27], v[48:51]
    v_mfma_f32_16x16x32_bf16 v[52:55], v[164:167], v[28:31], v[52:55]
    v_mfma_f32_16x16x32_bf16 v[56:59], v[172:175], v[24:27], v[56:59]
    v_mfma_f32_16x16x32_bf16 v[60:63], v[172:175], v[28:31], v[60:63]
    v_mfma_f32_16x16x32_bf16 v[64:67], a[36:39], v[24:27], v[64:67]
    v_mfma_f32_16x16x32_bf16 v[68:71], a[36:39], v[28:31], v[68:71]
    v_mfma_f32_16x16x32_bf16 v[72:75], a[44:47], v[24:27], v[72:75]
    v_mfma_f32_16x16x32_bf16 v[76:79], a[44:47], v[28:31], v[76:79]
    ds_read_b128 v[24:27], v2 offset:18432
    ds_read_b128 v[28:31], v2 offset:19456
    s_waitcnt lgkmcnt(6)
    v_mfma_f32_16x16x32_bf16 v[48:51], v[176:179], v[32:35], v[48:51]
    v_mfma_f32_16x16x32_bf16 v[52:55], v[176:179], v[36:39], v[52:55]
    v_mfma_f32_16x16x32_bf16 v[56:59], v[184:187], v[32:35], v[56:59]
    v_mfma_f32_16x16x32_bf16 v[60:63], v[184:187], v[36:39], v[60:63]
    v_mfma_f32_16x16x32_bf16 v[64:67], a[48:51], v[32:35], v[64:67]
    v_mfma_f32_16x16x32_bf16 v[68:71], a[48:51], v[36:39], v[68:71]
    v_mfma_f32_16x16x32_bf16 v[72:75], a[56:59], v[32:35], v[72:75]
    v_mfma_f32_16x16x32_bf16 v[76:79], a[56:59], v[36:39], v[76:79]
    ds_read_b128 v[32:35], v2 offset:20480
    ds_read_b128 v[36:39], v2 offset:21504
    s_waitcnt lgkmcnt(6)
    v_mfma_f32_16x16x32_bf16 v[48:51], v[180:183], v[40:43], v[48:51]
    v_mfma_f32_16x16x32_bf16 v[52:55], v[180:183], v[44:47], v[52:55]
    v_mfma_f32_16x16x32_bf16 v[56:59], v[188:191], v[40:43], v[56:59]
    v_mfma_f32_16x16x32_bf16 v[60:63], v[188:191], v[44:47], v[60:63]
    v_mfma_f32_16x16x32_bf16 v[64:67], a[52:55], v[40:43], v[64:67]
    v_mfma_f32_16x16x32_bf16 v[68:71], a[52:55], v[44:47], v[68:71]
    v_mfma_f32_16x16x32_bf16 v[72:75], a[60:63], v[40:43], v[72:75]
    v_mfma_f32_16x16x32_bf16 v[76:79], a[60:63], v[44:47], v[76:79]
    ds_read_b128 v[40:43], v2 offset:22528
    ds_read_b128 v[44:47], v2 offset:23552
    s_waitcnt lgkmcnt(6)
    v_mfma_f32_16x16x32_bf16 v[48:51], v[192:195], v[16:19], v[48:51]
    v_mfma_f32_16x16x32_bf16 v[52:55], v[192:195], v[20:23], v[52:55]
    v_mfma_f32_16x16x32_bf16 v[56:59], v[200:203], v[16:19], v[56:59]
    v_mfma_f32_16x16x32_bf16 v[60:63], v[200:203], v[20:23], v[60:63]
    v_mfma_f32_16x16x32_bf16 v[64:67], a[64:67], v[16:19], v[64:67]
    v_mfma_f32_16x16x32_bf16 v[68:71], a[64:67], v[20:23], v[68:71]
    v_mfma_f32_16x16x32_bf16 v[72:75], a[72:75], v[16:19], v[72:75]
    v_mfma_f32_16x16x32_bf16 v[76:79], a[72:75], v[20:23], v[76:79]
    s_waitcnt vmcnt(8)
    s_mov_b64 exec, 1
    buffer_store_dword v3, off, s[52:55], s68 sc1
    s_mov_b64 exec, -1
    ds_read_b128 v[16:19], v2 offset:24576
    ds_read_b128 v[20:23], v2 offset:25600
    s_waitcnt lgkmcnt(6)
    v_mfma_f32_16x16x32_bf16 v[48:51], v[196:199], v[24:27], v[48:51]
    v_mfma_f32_16x16x32_bf16 v[52:55], v[196:199], v[28:31], v[52:55]
    v_mfma_f32_16x16x32_bf16 v[56:59], v[204:207], v[24:27], v[56:59]
    v_mfma_f32_16x16x32_bf16 v[60:63], v[204:207], v[28:31], v[60:63]
    v_mfma_f32_16x16x32_bf16 v[64:67], a[68:71], v[24:27], v[64:67]
    v_mfma_f32_16x16x32_bf16 v[68:71], a[68:71], v[28:31], v[68:71]
    v_mfma_f32_16x16x32_bf16 v[72:75], a[76:79], v[24:27], v[72:75]
    v_mfma_f32_16x16x32_bf16 v[76:79], a[76:79], v[28:31], v[76:79]
    ds_read_b128 v[24:27], v2 offset:26624
    ds_read_b128 v[28:31], v2 offset:27648
    s_waitcnt lgkmcnt(6)
    v_mfma_f32_16x16x32_bf16 v[48:51], v[208:211], v[32:35], v[48:51]
    v_mfma_f32_16x16x32_bf16 v[52:55], v[208:211], v[36:39], v[52:55]
    v_mfma_f32_16x16x32_bf16 v[56:59], v[216:219], v[32:35], v[56:59]
    v_mfma_f32_16x16x32_bf16 v[60:63], v[216:219], v[36:39], v[60:63]
    v_mfma_f32_16x16x32_bf16 v[64:67], a[80:83], v[32:35], v[64:67]
    v_mfma_f32_16x16x32_bf16 v[68:71], a[80:83], v[36:39], v[68:71]
    v_mfma_f32_16x16x32_bf16 v[72:75], a[88:91], v[32:35], v[72:75]
    v_mfma_f32_16x16x32_bf16 v[76:79], a[88:91], v[36:39], v[76:79]
    ds_read_b128 v[32:35], v2 offset:28672
    ds_read_b128 v[36:39], v2 offset:29696
    s_waitcnt lgkmcnt(6)
    v_mfma_f32_16x16x32_bf16 v[48:51], v[212:215], v[40:43], v[48:51]
    v_mfma_f32_16x16x32_bf16 v[52:55], v[212:215], v[44:47], v[52:55]
    v_mfma_f32_16x16x32_bf16 v[56:59], v[220:223], v[40:43], v[56:59]
    v_mfma_f32_16x16x32_bf16 v[60:63], v[220:223], v[44:47], v[60:63]
    v_mfma_f32_16x16x32_bf16 v[64:67], a[84:87], v[40:43], v[64:67]
    v_mfma_f32_16x16x32_bf16 v[68:71], a[84:87], v[44:47], v[68:71]
    v_mfma_f32_16x16x32_bf16 v[72:75], a[92:95], v[40:43], v[72:75]
    v_mfma_f32_16x16x32_bf16 v[76:79], a[92:95], v[44:47], v[76:79]
    ds_read_b128 v[40:43], v2 offset:30720
    ds_read_b128 v[44:47], v2 offset:31744
    s_waitcnt lgkmcnt(6)
    v_mfma_f32_16x16x32_bf16 v[48:51], v[224:227], v[16:19], v[48:51]
    v_mfma_f32_16x16x32_bf16 v[52:55], v[224:227], v[20:23], v[52:55]
    v_mfma_f32_16x16x32_bf16 v[56:59], v[232:235], v[16:19], v[56:59]
    v_mfma_f32_16x16x32_bf16 v[60:63], v[232:235], v[20:23], v[60:63]
    v_mfma_f32_16x16x32_bf16 v[64:67], a[96:99], v[16:19], v[64:67]
    v_mfma_f32_16x16x32_bf16 v[68:71], a[96:99], v[20:23], v[68:71]
    v_mfma_f32_16x16x32_bf16 v[72:75], a[104:107], v[16:19], v[72:75]
    v_mfma_f32_16x16x32_bf16 v[76:79], a[104:107], v[20:23], v[76:79]
    s_waitcnt lgkmcnt(4)
    v_mfma_f32_16x16x32_bf16 v[48:51], v[228:231], v[24:27], v[48:51]
    v_mfma_f32_16x16x32_bf16 v[52:55], v[228:231], v[28:31], v[52:55]
    v_mfma_f32_16x16x32_bf16 v[56:59], v[236:239], v[24:27], v[56:59]
    v_mfma_f32_16x16x32_bf16 v[60:63], v[236:239], v[28:31], v[60:63]
    v_mfma_f32_16x16x32_bf16 v[64:67], a[100:103], v[24:27], v[64:67]
    v_mfma_f32_16x16x32_bf16 v[68:71], a[100:103], v[28:31], v[68:71]
    v_mfma_f32_16x16x32_bf16 v[72:75], a[108:111], v[24:27], v[72:75]
    v_mfma_f32_16x16x32_bf16 v[76:79], a[108:111], v[28:31], v[76:79]
    s_waitcnt lgkmcnt(2)
    v_mfma_f32_16x16x32_bf16 v[48:51], v[240:243], v[32:35], v[48:51]
    v_mfma_f32_16x16x32_bf16 v[52:55], v[240:243], v[36:39], v[52:55]
    v_mfma_f32_16x16x32_bf16 v[56:59], v[248:251], v[32:35], v[56:59]
    v_mfma_f32_16x16x32_bf16 v[60:63], v[248:251], v[36:39], v[60:63]
    v_mfma_f32_16x16x32_bf16 v[64:67], a[112:115], v[32:35], v[64:67]
    v_mfma_f32_16x16x32_bf16 v[68:71], a[112:115], v[36:39], v[68:71]
    v_mfma_f32_16x16x32_bf16 v[72:75], a[120:123], v[32:35], v[72:75]
    v_mfma_f32_16x16x32_bf16 v[76:79], a[120:123], v[36:39], v[76:79]
    s_waitcnt lgkmcnt(0)
    v_mfma_f32_16x16x32_bf16 v[48:51], v[244:247], v[40:43], v[48:51]
    v_mfma_f32_16x16x32_bf16 v[52:55], v[244:247], v[44:47], v[52:55]
    v_mfma_f32_16x16x32_bf16 v[56:59], v[252:255], v[40:43], v[56:59]
    v_mfma_f32_16x16x32_bf16 v[60:63], v[252:255], v[44:47], v[60:63]
    v_mfma_f32_16x16x32_bf16 v[64:67], a[116:119], v[40:43], v[64:67]
    v_mfma_f32_16x16x32_bf16 v[68:71], a[116:119], v[44:47], v[68:71]
    v_mfma_f32_16x16x32_bf16 v[72:75], a[124:127], v[40:43], v[72:75]
    v_mfma_f32_16x16x32_bf16 v[76:79], a[124:127], v[44:47], v[76:79]
    s_and_b32 s3, s65, 3
    s_cmp_lg_u32 s3, 3
    s_cbranch_scc1 .tw14
    s_cmp_gt_u32 s64, 3
    s_cbranch_scc1 .tw14
    s_lshl_b32 s3, s64, 2
    s_add_u32 s3, s3, s56
    s_lshl_b32 s4, s3, 18
    s_lshl_b32 s5, s63, 8
    s_add_u32 s4, s4, s5
    s_lshl_b32 s3, s3, 13
    s_lshl_b32 s5, s63, 17
    s_add_u32 s3, s3, s5
    v_lshlrev_b32 v125, 3, v0
    v_and_b32 v126, 0x3e0, v0
    v_and_b32 v127, 0x80, v125
    v_lshl_or_b32 v126, v126, 8, v127
    buffer_load_dword v124, v126, s[20:23], s4 offen
    buffer_load_dword v124, v126, s[24:27], s4 offen
    buffer_load_dword v124, v125, s[28:31], s3 offen
.tw14:
    v_mul_f32 v80, 0xbfb8aa3b, v48
    v_mul_f32 v81, 0xbfb8aa3b, v49
    v_mul_f32 v82, 0xbfb8aa3b, v50
    v_mul_f32 v83, 0xbfb8aa3b, v51
    v_mul_f32 v84, 0xbfb8aa3b, v52
    v_mul_f32 v85, 0xbfb8aa3b, v53
    v_mul_f32 v86, 0xbfb8aa3b, v54
    v_mul_f32 v87, 0xbfb8aa3b, v55
    v_mul_f32 v88, 0xbfb8aa3b, v56
    v_mul_f32 v89, 0xbfb8aa3b, v57
    v_mul_f32 v90, 0xbfb8aa3b, v58
    v_mul_f32 v91, 0xbfb8aa3b, v59
    v_mul_f32 v92, 0xbfb8aa3b, v60
    v_mul_f32 v93, 0xbfb8aa3b, v61
    v_mul_f32 v94, 0xbfb8aa3b, v62
    v_mul_f32 v95, 0xbfb8aa3b, v63
    v_exp_f32 v80, v80
    v_exp_f32 v81, v81
    v_exp_f32 v82, v82
    v_exp_f32 v83, v83
    v_exp_f32 v84, v84
    v_exp_f32 v85, v85
    v_exp_f32 v86, v86
    v_exp_f32 v87, v87
    v_exp_f32 v88, v88
    v_exp_f32 v89, v89
    v_exp_f32 v90, v90
    v_exp_f32 v91, v91
    v_exp_f32 v92, v92
    v_exp_f32 v93, v93
    v_exp_f32 v94, v94
    v_exp_f32 v95, v95
    v_add_f32 v80, 1.0, v80
    v_add_f32 v81, 1.0, v81
    v_add_f32 v82, 1.0, v82
    v_add_f32 v83, 1.0, v83
    v_add_f32 v84, 1.0, v84
    v_add_f32 v85, 1.0, v85
    v_add_f32 v86, 1.0, v86
    v_add_f32 v87, 1.0, v87
    v_add_f32 v88, 1.0, v88
    v_add_f32 v89, 1.0, v89
    v_add_f32 v90, 1.0, v90
    v_add_f32 v91, 1.0, v91
    v_add_f32 v92, 1.0, v92
    v_add_f32 v93, 1.0, v93
    v_add_f32 v94, 1.0, v94
    v_add_f32 v95, 1.0, v95
    v_rcp_f32 v80, v80
    v_rcp_f32 v81, v81
    v_rcp_f32 v82, v82
    v_rcp_f32 v83, v83
    v_rcp_f32 v84, v84
    v_rcp_f32 v85, v85
    v_rcp_f32 v86, v86
    v_rcp_f32 v87, v87
    v_rcp_f32 v88, v88
    v_rcp_f32 v89, v89
    v_rcp_f32 v90, v90
    v_rcp_f32 v91, v91
    v_rcp_f32 v92, v92
    v_rcp_f32 v93, v93
    v_rcp_f32 v94, v94
    v_rcp_f32 v95, v95
    v_mul_f32 v48, v48, v64
    v_mul_f32 v49, v49, v65
    v_mul_f32 v50, v50, v66
    v_mul_f32 v51, v51, v67
    v_mul_f32 v52, v52, v68
    v_mul_f32 v53, v53, v69
    v_mul_f32 v54, v54, v70
    v_mul_f32 v55, v55, v71
    v_mul_f32 v56, v56, v72
    v_mul_f32 v57, v57, v73
    v_mul_f32 v58, v58, v74
    v_mul_f32 v59, v59, v75
    v_mul_f32 v60, v60, v76
    v_mul_f32 v61, v61, v77
    v_mul_f32 v62, v62, v78
    v_mul_f32 v63, v63, v79
    v_mul_f32 v48, v48, v80
    v_mul_f32 v49, v49, v81
    v_mul_f32 v50, v50, v82
    v_mul_f32 v51, v51, v83
    v_mul_f32 v52, v52, v84
    v_mul_f32 v53, v53, v85
    v_mul_f32 v54, v54, v86
    v_mul_f32 v55, v55, v87
    v_mul_f32 v56, v56, v88
    v_mul_f32 v57, v57, v89
    v_mul_f32 v58, v58, v90
    v_mul_f32 v59, v59, v91
    v_mul_f32 v60, v60, v92
    v_mul_f32 v61, v61, v93
    v_mul_f32 v62, v62, v94
    v_mul_f32 v63, v63, v95
    v_cvt_pk_bf16_f32 v96, v48, v49
    v_cvt_pk_bf16_f32 v97, v50, v51
    v_cvt_pk_bf16_f32 v98, v56, v57
    v_cvt_pk_bf16_f32 v99, v58, v59
    ds_write_b128 v5, v[96:99] offset:0
    v_cvt_pk_bf16_f32 v100, v52, v53
    v_cvt_pk_bf16_f32 v101, v54, v55
    v_cvt_pk_bf16_f32 v102, v60, v61
    v_cvt_pk_bf16_f32 v103, v62, v63
    ds_write_b128 v5, v[100:103] offset:4096
    s_lshl_b32 s3, s65, 2
    s_add_u32 s3, s3, s56
    s_lshl_b32 s68, s3, 6
    s_add_u32 s68, s68, s70
    s_lshl_b32 s68, s68, 2
    s_add_u32 s68, s68, 167837824
    s_mul_i32 s3, s3, 368
    s_add_u32 s3, s3, s70
    s_lshl_b32 s3, s3, 10
    s_add_u32 s69, s3, 70287360
    s_waitcnt lgkmcnt(0)
    s_barrier
    ds_read_b128 v[16:19], v4 offset:0
    ds_read_b128 v[32:35], v4 offset:4096
    ds_read_b128 v[20:23], v4 offset:1024
    ds_read_b128 v[36:39], v4 offset:5120
    ds_read_b128 v[24:27], v4 offset:2048
    ds_read_b128 v[40:43], v4 offset:6144
    ds_read_b128 v[28:31], v4 offset:3072
    ds_read_b128 v[44:47], v4 offset:7168
    s_waitcnt lgkmcnt(6)
    v_mfma_f32_16x16x32_bf16 v[48:51], a[128:131], v[16:19], 0
    v_mfma_f32_16x16x32_bf16 v[52:55], a[128:131], v[32:35], 0
    v_mfma_f32_16x16x32_bf16 v[56:59], a[136:139], v[16:19], 0
    v_mfma_f32_16x16x32_bf16 v[60:63], a[136:139], v[32:35], 0
    s_waitcnt lgkmcnt(4)
    v_mfma_f32_16x16x32_bf16 v[48:51], a[132:135], v[20:23], v[48:51]
    v_mfma_f32_16x16x32_bf16 v[52:55], a[132:135], v[36:39], v[52:55]
    v_mfma_f32_16x16x32_bf16 v[56:59], a[140:143], v[20:23], v[56:59]
    v_mfma_f32_16x16x32_bf16 v[60:63], a[140:143], v[36:39], v[60:63]
    s_waitcnt lgkmcnt(2)
    v_mfma_f32_16x16x32_bf16 v[48:51], a[144:147], v[24:27], v[48:51]
    v_mfma_f32_16x16x32_bf16 v[52:55], a[144:147], v[40:43], v[52:55]
    v_mfma_f32_16x16x32_bf16 v[56:59], a[152:155], v[24:27], v[56:59]
    v_mfma_f32_16x16x32_bf16 v[60:63], a[152:155], v[40:43], v[60:63]
    s_waitcnt lgkmcnt(0)
    v_mfma_f32_16x16x32_bf16 v[48:51], a[148:151], v[28:31], v[48:51]
    v_mfma_f32_16x16x32_bf16 v[52:55], a[148:151], v[44:47], v[52:55]
    v_mfma_f32_16x16x32_bf16 v[56:59], a[156:159], v[28:31], v[56:59]
    v_mfma_f32_16x16x32_bf16 v[60:63], a[156:159], v[44:47], v[60:63]
    v_mfma_f32_16x16x32_bf16 v[64:67], a[160:163], v[16:19], 0
    v_mfma_f32_16x16x32_bf16 v[68:71], a[160:163], v[32:35], 0
    v_mfma_f32_16x16x32_bf16 v[72:75], a[168:171], v[16:19], 0
    v_mfma_f32_16x16x32_bf16 v[76:79], a[168:171], v[32:35], 0
    v_mfma_f32_16x16x32_bf16 v[64:67], a[164:167], v[20:23], v[64:67]
    v_mfma_f32_16x16x32_bf16 v[68:71], a[164:167], v[36:39], v[68:71]
    v_mfma_f32_16x16x32_bf16 v[72:75], a[172:175], v[20:23], v[72:75]
    v_mfma_f32_16x16x32_bf16 v[76:79], a[172:175], v[36:39], v[76:79]
    v_cvt_pk_bf16_f32 v96, v48, v49
    v_cvt_pk_bf16_f32 v97, v50, v51
    v_cvt_pk_bf16_f32 v98, v56, v57
    v_cvt_pk_bf16_f32 v99, v58, v59
    s_add_u32 s3, s69, 0
    buffer_store_dwordx4 v[96:99], v0, s[52:55], s3 offen sc1
    v_cvt_pk_bf16_f32 v100, v52, v53
    v_cvt_pk_bf16_f32 v101, v54, v55
    v_cvt_pk_bf16_f32 v102, v60, v61
    v_cvt_pk_bf16_f32 v103, v62, v63
    s_add_u32 s3, s69, 47104
    buffer_store_dwordx4 v[100:103], v0, s[52:55], s3 offen sc1
    v_mfma_f32_16x16x32_bf16 v[64:67], a[176:179], v[24:27], v[64:67]
    v_mfma_f32_16x16x32_bf16 v[68:71], a[176:179], v[40:43], v[68:71]
    v_mfma_f32_16x16x32_bf16 v[72:75], a[184:187], v[24:27], v[72:75]
    v_mfma_f32_16x16x32_bf16 v[76:79], a[184:187], v[40:43], v[76:79]
    v_mfma_f32_16x16x32_bf16 v[64:67], a[180:183], v[28:31], v[64:67]
    v_mfma_f32_16x16x32_bf16 v[68:71], a[180:183], v[44:47], v[68:71]
    v_mfma_f32_16x16x32_bf16 v[72:75], a[188:191], v[28:31], v[72:75]
    v_mfma_f32_16x16x32_bf16 v[76:79], a[188:191], v[44:47], v[76:79]
    v_mfma_f32_16x16x32_bf16 v[48:51], a[192:195], v[16:19], 0
    v_mfma_f32_16x16x32_bf16 v[52:55], a[192:195], v[32:35], 0
    v_mfma_f32_16x16x32_bf16 v[56:59], a[200:203], v[16:19], 0
    v_mfma_f32_16x16x32_bf16 v[60:63], a[200:203], v[32:35], 0
    v_mfma_f32_16x16x32_bf16 v[48:51], a[196:199], v[20:23], v[48:51]
    v_mfma_f32_16x16x32_bf16 v[52:55], a[196:199], v[36:39], v[52:55]
    v_mfma_f32_16x16x32_bf16 v[56:59], a[204:207], v[20:23], v[56:59]
    v_mfma_f32_16x16x32_bf16 v[60:63], a[204:207], v[36:39], v[60:63]
    v_cvt_pk_bf16_f32 v104, v64, v65
    v_cvt_pk_bf16_f32 v105, v66, v67
    v_cvt_pk_bf16_f32 v106, v72, v73
    v_cvt_pk_bf16_f32 v107, v74, v75
    s_add_u32 s3, s69, 94208
    buffer_store_dwordx4 v[104:107], v0, s[52:55], s3 offen sc1
    v_cvt_pk_bf16_f32 v108, v68, v69
    v_cvt_pk_bf16_f32 v109, v70, v71
    v_cvt_pk_bf16_f32 v110, v76, v77
    v_cvt_pk_bf16_f32 v111, v78, v79
    s_add_u32 s3, s69, 141312
    buffer_store_dwordx4 v[108:111], v0, s[52:55], s3 offen sc1
    v_mfma_f32_16x16x32_bf16 v[48:51], a[208:211], v[24:27], v[48:51]
    v_mfma_f32_16x16x32_bf16 v[52:55], a[208:211], v[40:43], v[52:55]
    v_mfma_f32_16x16x32_bf16 v[56:59], a[216:219], v[24:27], v[56:59]
    v_mfma_f32_16x16x32_bf16 v[60:63], a[216:219], v[40:43], v[60:63]
    v_mfma_f32_16x16x32_bf16 v[48:51], a[212:215], v[28:31], v[48:51]
    v_mfma_f32_16x16x32_bf16 v[52:55], a[212:215], v[44:47], v[52:55]
    v_mfma_f32_16x16x32_bf16 v[56:59], a[220:223], v[28:31], v[56:59]
    v_mfma_f32_16x16x32_bf16 v[60:63], a[220:223], v[44:47], v[60:63]
    v_mfma_f32_16x16x32_bf16 v[64:67], a[224:227], v[16:19], 0
    v_mfma_f32_16x16x32_bf16 v[68:71], a[224:227], v[32:35], 0
    v_mfma_f32_16x16x32_bf16 v[72:75], a[232:235], v[16:19], 0
    v_mfma_f32_16x16x32_bf16 v[76:79], a[232:235], v[32:35], 0
    v_mfma_f32_16x16x32_bf16 v[64:67], a[228:231], v[20:23], v[64:67]
    v_mfma_f32_16x16x32_bf16 v[68:71], a[228:231], v[36:39], v[68:71]
    v_mfma_f32_16x16x32_bf16 v[72:75], a[236:239], v[20:23], v[72:75]
    v_mfma_f32_16x16x32_bf16 v[76:79], a[236:239], v[36:39], v[76:79]
    v_cvt_pk_bf16_f32 v96, v48, v49
    v_cvt_pk_bf16_f32 v97, v50, v51
    v_cvt_pk_bf16_f32 v98, v56, v57
    v_cvt_pk_bf16_f32 v99, v58, v59
    s_add_u32 s3, s69, 188416
    buffer_store_dwordx4 v[96:99], v0, s[52:55], s3 offen sc1
    v_cvt_pk_bf16_f32 v100, v52, v53
    v_cvt_pk_bf16_f32 v101, v54, v55
    v_cvt_pk_bf16_f32 v102, v60, v61
    v_cvt_pk_bf16_f32 v103, v62, v63
    s_add_u32 s3, s69, 235520
    buffer_store_dwordx4 v[100:103], v0, s[52:55], s3 offen sc1
    v_mfma_f32_16x16x32_bf16 v[64:67], a[240:243], v[24:27], v[64:67]
    v_mfma_f32_16x16x32_bf16 v[68:71], a[240:243], v[40:43], v[68:71]
    v_mfma_f32_16x16x32_bf16 v[72:75], a[248:251], v[24:27], v[72:75]
    v_mfma_f32_16x16x32_bf16 v[76:79], a[248:251], v[40:43], v[76:79]
    v_mfma_f32_16x16x32_bf16 v[64:67], a[244:247], v[28:31], v[64:67]
    v_mfma_f32_16x16x32_bf16 v[68:71], a[244:247], v[44:47], v[68:71]
    v_mfma_f32_16x16x32_bf16 v[72:75], a[252:255], v[28:31], v[72:75]
    v_mfma_f32_16x16x32_bf16 v[76:79], a[252:255], v[44:47], v[76:79]
    v_cvt_pk_bf16_f32 v104, v64, v65
    v_cvt_pk_bf16_f32 v105, v66, v67
    s_nop 0
    v_cvt_pk_bf16_f32 v106, v72, v73
    v_cvt_pk_bf16_f32 v107, v74, v75
    s_add_u32 s3, s69, 282624
    buffer_store_dwordx4 v[104:107], v0, s[52:55], s3 offen sc1
    v_cvt_pk_bf16_f32 v108, v68, v69
    v_cvt_pk_bf16_f32 v109, v70, v71
    v_cvt_pk_bf16_f32 v110, v76, v77
    v_cvt_pk_bf16_f32 v111, v78, v79
    s_add_u32 s3, s69, 329728
    buffer_store_dwordx4 v[108:111], v0, s[52:55], s3 offen sc1
    v_xor_b32 v2, 0x8000, v2
    s_mov_b32 s65, s67
    s_and_b32 s3, s65, 3
    s_cmp_lg_u32 s3, 0
    s_cbranch_scc1 .ffn13
    s_waitcnt vmcnt(0)
    s_mov_b64 exec, 1
    buffer_store_dword v3, off, s[52:55], s68 sc1
    s_mov_b64 exec, -1
    s_barrier
    s_lshl_b32 s67, s63, 17
    s_lshl_b32 s71, s63, 8
    v_bfe_u32 v20, v0, 6, 1
    v_lshlrev_b32 v16, 2, v20
    v_bfe_u32 v20, v0, 7, 1
    v_lshl_or_b32 v16, v20, 3, v16
    v_bfe_u32 v20, v0, 8, 1
    v_lshl_or_b32 v16, v20, 0, v16
    v_bfe_u32 v20, v0, 9, 1
    v_lshl_or_b32 v16, v20, 1, v16
    s_mov_b32 s3, 8192
    v_mul_lo_u32 v16, v16, s3
    v_and_b32 v20, 0x30, v0
    s_lshl_b32 s3, s56, 6
    v_add3_u32 v16, v16, v20, s3
    v_add_u32 v17, 1047552, v16
    v_add_u32 v18, 2095104, v16
    v_add_u32 v19, 3142656, v16
    s_add_u32 s3, s62, 1
    s_and_b32 s4, s3, 15
    s_lshl_b32 s4, s4, 12
    s_lshr_b32 s3, s3, 4
    s_lshl_b32 s3, s3, 2
    s_add_u32 s3, s3, s4
    s_add_u32 s69, s3, 167837824
    buffer_load_dword v127, off, s[52:55], s69 sc1
    s_add_u32 m0, s61, 0
    s_add_u32 s3, s71, 0
    buffer_load_dwordx4 v16, s[20:23], s3 offen offset:0 lds
    buffer_load_dwordx4 v17, s[20:23], s3 offen offset:1024 lds
    buffer_load_dwordx4 v18, s[20:23], s3 offen offset:2048 lds
    buffer_load_dwordx4 v19, s[20:23], s3 offen offset:3072 lds
    s_add_u32 m0, s61, 4096
    s_add_u32 s3, s71, 524288
    buffer_load_dwordx4 v16, s[20:23], s3 offen offset:0 lds
    buffer_load_dwordx4 v17, s[20:23], s3 offen offset:1024 lds
    buffer_load_dwordx4 v18, s[20:23], s3 offen offset:2048 lds
    buffer_load_dwordx4 v19, s[20:23], s3 offen offset:3072 lds
    s_add_u32 m0, s61, 8192
    s_add_u32 s3, s71, 131072
    buffer_load_dwordx4 v16, s[20:23], s3 offen offset:0 lds
    buffer_load_dwordx4 v17, s[20:23], s3 offen offset:1024 lds
    buffer_load_dwordx4 v18, s[20:23], s3 offen offset:2048 lds
    buffer_load_dwordx4 v19, s[20:23], s3 offen offset:3072 lds
    s_add_u32 m0, s61, 12288
    s_add_u32 s3, s71, 655360
    buffer_load_dwordx4 v16, s[20:23], s3 offen offset:0 lds
    buffer_load_dwordx4 v17, s[20:23], s3 offen offset:1024 lds
    buffer_load_dwordx4 v18, s[20:23], s3 offen offset:2048 lds
    buffer_load_dwordx4 v19, s[20:23], s3 offen offset:3072 lds
    s_add_u32 m0, s61, 16384
    s_add_u32 s3, s71, 262144
    buffer_load_dwordx4 v16, s[20:23], s3 offen offset:0 lds
    buffer_load_dwordx4 v17, s[20:23], s3 offen offset:1024 lds
    buffer_load_dwordx4 v18, s[20:23], s3 offen offset:2048 lds
    buffer_load_dwordx4 v19, s[20:23], s3 offen offset:3072 lds
    s_add_u32 m0, s61, 20480
    s_add_u32 s3, s71, 786432
    buffer_load_dwordx4 v16, s[20:23], s3 offen offset:0 lds
    buffer_load_dwordx4 v17, s[20:23], s3 offen offset:1024 lds
    buffer_load_dwordx4 v18, s[20:23], s3 offen offset:2048 lds
    buffer_load_dwordx4 v19, s[20:23], s3 offen offset:3072 lds
    s_add_u32 m0, s61, 24576
    s_add_u32 s3, s71, 393216
    buffer_load_dwordx4 v16, s[20:23], s3 offen offset:0 lds
    buffer_load_dwordx4 v17, s[20:23], s3 offen offset:1024 lds
    buffer_load_dwordx4 v18, s[20:23], s3 offen offset:2048 lds
    buffer_load_dwordx4 v19, s[20:23], s3 offen offset:3072 lds
    s_add_u32 m0, s61, 28672
    s_add_u32 s3, s71, 917504
    buffer_load_dwordx4 v16, s[20:23], s3 offen offset:0 lds
    buffer_load_dwordx4 v17, s[20:23], s3 offen offset:1024 lds
    buffer_load_dwordx4 v18, s[20:23], s3 offen offset:2048 lds
    buffer_load_dwordx4 v19, s[20:23], s3 offen offset:3072 lds
    s_waitcnt vmcnt(28)
    ds_read_b64_tr_b16 v[128:129], v1 offset:0
    ds_read_b64_tr_b16 v[130:131], v1 offset:256
    ds_read_b64_tr_b16 v[132:133], v1 offset:2048
    ds_read_b64_tr_b16 v[134:135], v1 offset:2304
    ds_read_b64_tr_b16 v[136:137], v1 offset:8
    ds_read_b64_tr_b16 v[138:139], v1 offset:264
    ds_read_b64_tr_b16 v[140:141], v1 offset:2056
    ds_read_b64_tr_b16 v[142:143], v1 offset:2312
    s_waitcnt lgkmcnt(0)
    s_add_u32 m0, s61, 0
    s_add_u32 s3, s71, 0
    buffer_load_dwordx4 v16, s[24:27], s3 offen offset:0 lds
    buffer_load_dwordx4 v17, s[24:27], s3 offen offset:1024 lds
    buffer_load_dwordx4 v18, s[24:27], s3 offen offset:2048 lds
    buffer_load_dwordx4 v19, s[24:27], s3 offen offset:3072 lds
    s_waitcnt vmcnt(28)
    ds_read_b64_tr_b16 v[144:145], v1 offset:4096
    ds_read_b64_tr_b16 v[146:147], v1 offset:4352
    ds_read_b64_tr_b16 v[148:149], v1 offset:6144
    ds_read_b64_tr_b16 v[150:151], v1 offset:6400
    ds_read_b64_tr_b16 v[152:153], v1 offset:4104
    ds_read_b64_tr_b16 v[154:155], v1 offset:4360
    ds_read_b64_tr_b16 v[156:157], v1 offset:6152
    ds_read_b64_tr_b16 v[158:159], v1 offset:6408
    s_waitcnt lgkmcnt(0)
    s_add_u32 m0, s61, 4096
    s_add_u32 s3, s71, 524288
    buffer_load_dwordx4 v16, s[24:27], s3 offen offset:0 lds
    buffer_load_dwordx4 v17, s[24:27], s3 offen offset:1024 lds
    buffer_load_dwordx4 v18, s[24:27], s3 offen offset:2048 lds
    buffer_load_dwordx4 v19, s[24:27], s3 offen offset:3072 lds
    s_waitcnt vmcnt(28)
    ds_read_b64_tr_b16 v[160:161], v1 offset:8192
    ds_read_b64_tr_b16 v[162:163], v1 offset:8448
    ds_read_b64_tr_b16 v[164:165], v1 offset:10240
    ds_read_b64_tr_b16 v[166:167], v1 offset:10496
    ds_read_b64_tr_b16 v[168:169], v1 offset:8200
    ds_read_b64_tr_b16 v[170:171], v1 offset:8456
    ds_read_b64_tr_b16 v[172:173], v1 offset:10248
    ds_read_b64_tr_b16 v[174:175], v1 offset:10504
    s_waitcnt lgkmcnt(0)
    s_add_u32 m0, s61, 8192
    s_add_u32 s3, s71, 131072
    buffer_load_dwordx4 v16, s[24:27], s3 offen offset:0 lds
    buffer_load_dwordx4 v17, s[24:27], s3 offen offset:1024 lds
    buffer_load_dwordx4 v18, s[24:27], s3 offen offset:2048 lds
    buffer_load_dwordx4 v19, s[24:27], s3 offen offset:3072 lds
    s_waitcnt vmcnt(28)
    ds_read_b64_tr_b16 v[176:177], v1 offset:12288
    ds_read_b64_tr_b16 v[178:179], v1 offset:12544
    ds_read_b64_tr_b16 v[180:181], v1 offset:14336
    ds_read_b64_tr_b16 v[182:183], v1 offset:14592
    ds_read_b64_tr_b16 v[184:185], v1 offset:12296
    ds_read_b64_tr_b16 v[186:187], v1 offset:12552
    ds_read_b64_tr_b16 v[188:189], v1 offset:14344
    ds_read_b64_tr_b16 v[190:191], v1 offset:14600
    s_waitcnt lgkmcnt(0)
    s_add_u32 m0, s61, 12288
    s_add_u32 s3, s71, 655360
    buffer_load_dwordx4 v16, s[24:27], s3 offen offset:0 lds
    buffer_load_dwordx4 v17, s[24:27], s3 offen offset:1024 lds
    buffer_load_dwordx4 v18, s[24:27], s3 offen offset:2048 lds
    buffer_load_dwordx4 v19, s[24:27], s3 offen offset:3072 lds
    s_waitcnt vmcnt(28)
    ds_read_b64_tr_b16 v[192:193], v1 offset:16384
    ds_read_b64_tr_b16 v[194:195], v1 offset:16640
    ds_read_b64_tr_b16 v[196:197], v1 offset:18432
    ds_read_b64_tr_b16 v[198:199], v1 offset:18688
    ds_read_b64_tr_b16 v[200:201], v1 offset:16392
    ds_read_b64_tr_b16 v[202:203], v1 offset:16648
    ds_read_b64_tr_b16 v[204:205], v1 offset:18440
    ds_read_b64_tr_b16 v[206:207], v1 offset:18696
    s_waitcnt lgkmcnt(0)
    s_add_u32 m0, s61, 16384
    s_add_u32 s3, s71, 262144
    buffer_load_dwordx4 v16, s[24:27], s3 offen offset:0 lds
    buffer_load_dwordx4 v17, s[24:27], s3 offen offset:1024 lds
    buffer_load_dwordx4 v18, s[24:27], s3 offen offset:2048 lds
    buffer_load_dwordx4 v19, s[24:27], s3 offen offset:3072 lds
    s_waitcnt vmcnt(28)
    ds_read_b64_tr_b16 v[208:209], v1 offset:20480
    ds_read_b64_tr_b16 v[210:211], v1 offset:20736
    ds_read_b64_tr_b16 v[212:213], v1 offset:22528
    ds_read_b64_tr_b16 v[214:215], v1 offset:22784
    ds_read_b64_tr_b16 v[216:217], v1 offset:20488
    ds_read_b64_tr_b16 v[218:219], v1 offset:20744
    ds_read_b64_tr_b16 v[220:221], v1 offset:22536
    ds_read_b64_tr_b16 v[222:223], v1 offset:22792
    s_waitcnt lgkmcnt(0)
    s_add_u32 m0, s61, 20480
    s_add_u32 s3, s71, 786432
    buffer_load_dwordx4 v16, s[24:27], s3 offen offset:0 lds
    buffer_load_dwordx4 v17, s[24:27], s3 offen offset:1024 lds
    buffer_load_dwordx4 v18, s[24:27], s3 offen offset:2048 lds
    buffer_load_dwordx4 v19, s[24:27], s3 offen offset:3072 lds
    s_waitcnt vmcnt(28)
    ds_read_b64_tr_b16 v[224:225], v1 offset:24576
    ds_read_b64_tr_b16 v[226:227], v1 offset:24832
    ds_read_b64_tr_b16 v[228:229], v1 offset:26624
    ds_read_b64_tr_b16 v[230:231], v1 offset:26880
    ds_read_b64_tr_b16 v[232:233], v1 offset:24584
    ds_read_b64_tr_b16 v[234:235], v1 offset:24840
    ds_read_b64_tr_b16 v[236:237], v1 offset:26632
    ds_read_b64_tr_b16 v[238:239], v1 offset:26888
    s_waitcnt lgkmcnt(0)
    s_add_u32 m0, s61, 24576
    s_add_u32 s3, s71, 393216
    buffer_load_dwordx4 v16, s[24:27], s3 offen offset:0 lds
    buffer_load_dwordx4 v17, s[24:27], s3 offen offset:1024 lds
    buffer_load_dwordx4 v18, s[24:27], s3 offen offset:2048 lds
    buffer_load_dwordx4 v19, s[24:27], s3 offen offset:3072 lds
    s_waitcnt vmcnt(28)
    ds_read_b64_tr_b16 v[240:241], v1 offset:28672
    ds_read_b64_tr_b16 v[242:243], v1 offset:28928
    ds_read_b64_tr_b16 v[244:245], v1 offset:30720
    ds_read_b64_tr_b16 v[246:247], v1 offset:30976
    ds_read_b64_tr_b16 v[248:249], v1 offset:28680
    ds_read_b64_tr_b16 v[250:251], v1 offset:28936
    ds_read_b64_tr_b16 v[252:253], v1 offset:30728
    ds_read_b64_tr_b16 v[254:255], v1 offset:30984
    s_waitcnt lgkmcnt(0)
    s_add_u32 m0, s61, 28672
    s_add_u32 s3, s71, 917504
    buffer_load_dwordx4 v16, s[24:27], s3 offen offset:0 lds
    buffer_load_dwordx4 v17, s[24:27], s3 offen offset:1024 lds
    buffer_load_dwordx4 v18, s[24:27], s3 offen offset:2048 lds
    buffer_load_dwordx4 v19, s[24:27], s3 offen offset:3072 lds
    s_waitcnt vmcnt(28)
    ds_read_b64_tr_b16 a[0:1], v1 offset:0
    ds_read_b64_tr_b16 a[2:3], v1 offset:256
    ds_read_b64_tr_b16 a[4:5], v1 offset:2048
    ds_read_b64_tr_b16 a[6:7], v1 offset:2304
    ds_read_b64_tr_b16 a[8:9], v1 offset:8
    ds_read_b64_tr_b16 a[10:11], v1 offset:264
    ds_read_b64_tr_b16 a[12:13], v1 offset:2056
    ds_read_b64_tr_b16 a[14:15], v1 offset:2312
    s_waitcnt lgkmcnt(0)
    s_add_u32 m0, s61, 0
    s_add_u32 s3, s67, 0
    buffer_load_dwordx4 v12, s[28:31], s3 offen offset:0 lds
    buffer_load_dwordx4 v13, s[28:31], s3 offen offset:1024 lds
    buffer_load_dwordx4 v14, s[28:31], s3 offen offset:2048 lds
    buffer_load_dwordx4 v15, s[28:31], s3 offen offset:3072 lds
    s_waitcnt vmcnt(28)
    ds_read_b64_tr_b16 a[16:17], v1 offset:4096
    ds_read_b64_tr_b16 a[18:19], v1 offset:4352
    ds_read_b64_tr_b16 a[20:21], v1 offset:6144
    ds_read_b64_tr_b16 a[22:23], v1 offset:6400
    ds_read_b64_tr_b16 a[24:25], v1 offset:4104
    ds_read_b64_tr_b16 a[26:27], v1 offset:4360
    ds_read_b64_tr_b16 a[28:29], v1 offset:6152
    ds_read_b64_tr_b16 a[30:31], v1 offset:6408
    s_waitcnt lgkmcnt(0)
    s_add_u32 m0, s61, 4096
    s_add_u32 s3, s67, 65536
    buffer_load_dwordx4 v12, s[28:31], s3 offen offset:0 lds
    buffer_load_dwordx4 v13, s[28:31], s3 offen offset:1024 lds
    buffer_load_dwordx4 v14, s[28:31], s3 offen offset:2048 lds
    buffer_load_dwordx4 v15, s[28:31], s3 offen offset:3072 lds
    s_waitcnt vmcnt(28)
    ds_read_b64_tr_b16 a[32:33], v1 offset:8192
    ds_read_b64_tr_b16 a[34:35], v1 offset:8448
    ds_read_b64_tr_b16 a[36:37], v1 offset:10240
    ds_read_b64_tr_b16 a[38:39], v1 offset:10496
    ds_read_b64_tr_b16 a[40:41], v1 offset:8200
    ds_read_b64_tr_b16 a[42:43], v1 offset:8456
    ds_read_b64_tr_b16 a[44:45], v1 offset:10248
    ds_read_b64_tr_b16 a[46:47], v1 offset:10504
    s_waitcnt lgkmcnt(0)
    s_add_u32 m0, s61, 8192
    s_add_u32 s3, s67, 64
    buffer_load_dwordx4 v12, s[28:31], s3 offen offset:0 lds
    buffer_load_dwordx4 v13, s[28:31], s3 offen offset:1024 lds
    buffer_load_dwordx4 v14, s[28:31], s3 offen offset:2048 lds
    buffer_load_dwordx4 v15, s[28:31], s3 offen offset:3072 lds
    s_waitcnt vmcnt(28)
    ds_read_b64_tr_b16 a[48:49], v1 offset:12288
    ds_read_b64_tr_b16 a[50:51], v1 offset:12544
    ds_read_b64_tr_b16 a[52:53], v1 offset:14336
    ds_read_b64_tr_b16 a[54:55], v1 offset:14592
    ds_read_b64_tr_b16 a[56:57], v1 offset:12296
    ds_read_b64_tr_b16 a[58:59], v1 offset:12552
    ds_read_b64_tr_b16 a[60:61], v1 offset:14344
    ds_read_b64_tr_b16 a[62:63], v1 offset:14600
    s_waitcnt lgkmcnt(0)
    s_add_u32 m0, s61, 12288
    s_add_u32 s3, s67, 65600
    buffer_load_dwordx4 v12, s[28:31], s3 offen offset:0 lds
    buffer_load_dwordx4 v13, s[28:31], s3 offen offset:1024 lds
    buffer_load_dwordx4 v14, s[28:31], s3 offen offset:2048 lds
    buffer_load_dwordx4 v15, s[28:31], s3 offen offset:3072 lds
    s_waitcnt vmcnt(28)
    ds_read_b64_tr_b16 a[64:65], v1 offset:16384
    ds_read_b64_tr_b16 a[66:67], v1 offset:16640
    ds_read_b64_tr_b16 a[68:69], v1 offset:18432
    ds_read_b64_tr_b16 a[70:71], v1 offset:18688
    ds_read_b64_tr_b16 a[72:73], v1 offset:16392
    ds_read_b64_tr_b16 a[74:75], v1 offset:16648
    ds_read_b64_tr_b16 a[76:77], v1 offset:18440
    ds_read_b64_tr_b16 a[78:79], v1 offset:18696
    s_waitcnt lgkmcnt(0)
    s_add_u32 m0, s61, 16384
    s_add_u32 s3, s67, 128
    buffer_load_dwordx4 v12, s[28:31], s3 offen offset:0 lds
    buffer_load_dwordx4 v13, s[28:31], s3 offen offset:1024 lds
    buffer_load_dwordx4 v14, s[28:31], s3 offen offset:2048 lds
    buffer_load_dwordx4 v15, s[28:31], s3 offen offset:3072 lds
    s_waitcnt vmcnt(28)
    ds_read_b64_tr_b16 a[80:81], v1 offset:20480
    ds_read_b64_tr_b16 a[82:83], v1 offset:20736
    ds_read_b64_tr_b16 a[84:85], v1 offset:22528
    ds_read_b64_tr_b16 a[86:87], v1 offset:22784
    ds_read_b64_tr_b16 a[88:89], v1 offset:20488
    ds_read_b64_tr_b16 a[90:91], v1 offset:20744
    ds_read_b64_tr_b16 a[92:93], v1 offset:22536
    ds_read_b64_tr_b16 a[94:95], v1 offset:22792
    s_waitcnt lgkmcnt(0)
    s_add_u32 m0, s61, 20480
    s_add_u32 s3, s67, 65664
    buffer_load_dwordx4 v12, s[28:31], s3 offen offset:0 lds
    buffer_load_dwordx4 v13, s[28:31], s3 offen offset:1024 lds
    buffer_load_dwordx4 v14, s[28:31], s3 offen offset:2048 lds
    buffer_load_dwordx4 v15, s[28:31], s3 offen offset:3072 lds
    s_waitcnt vmcnt(28)
    ds_read_b64_tr_b16 a[96:97], v1 offset:24576
    ds_read_b64_tr_b16 a[98:99], v1 offset:24832
    ds_read_b64_tr_b16 a[100:101], v1 offset:26624
    ds_read_b64_tr_b16 a[102:103], v1 offset:26880
    ds_read_b64_tr_b16 a[104:105], v1 offset:24584
    ds_read_b64_tr_b16 a[106:107], v1 offset:24840
    ds_read_b64_tr_b16 a[108:109], v1 offset:26632
    ds_read_b64_tr_b16 a[110:111], v1 offset:26888
    s_waitcnt lgkmcnt(0)
    s_add_u32 m0, s61, 24576
    s_add_u32 s3, s67, 192
    buffer_load_dwordx4 v12, s[28:31], s3 offen offset:0 lds
    buffer_load_dwordx4 v13, s[28:31], s3 offen offset:1024 lds
    buffer_load_dwordx4 v14, s[28:31], s3 offen offset:2048 lds
    buffer_load_dwordx4 v15, s[28:31], s3 offen offset:3072 lds
    s_waitcnt vmcnt(28)
    ds_read_b64_tr_b16 a[112:113], v1 offset:28672
    ds_read_b64_tr_b16 a[114:115], v1 offset:28928
    ds_read_b64_tr_b16 a[116:117], v1 offset:30720
    ds_read_b64_tr_b16 a[118:119], v1 offset:30976
    ds_read_b64_tr_b16 a[120:121], v1 offset:28680
    ds_read_b64_tr_b16 a[122:123], v1 offset:28936
    ds_read_b64_tr_b16 a[124:125], v1 offset:30728
    ds_read_b64_tr_b16 a[126:127], v1 offset:30984
    s_waitcnt lgkmcnt(0)
    s_add_u32 m0, s61, 28672
    s_add_u32 s3, s67, 65728
    buffer_load_dwordx4 v12, s[28:31], s3 offen offset:0 lds
    buffer_load_dwordx4 v13, s[28:31], s3 offen offset:1024 lds
    buffer_load_dwordx4 v14, s[28:31], s3 offen offset:2048 lds
    buffer_load_dwordx4 v15, s[28:31], s3 offen offset:3072 lds
    s_waitcnt vmcnt(28)
    ds_read_b64_tr_b16 a[128:129], v1 offset:0
    ds_read_b64_tr_b16 a[130:131], v1 offset:256
    ds_read_b64_tr_b16 a[132:133], v1 offset:2048
    ds_read_b64_tr_b16 a[134:135], v1 offset:2304
    ds_read_b64_tr_b16 a[136:137], v1 offset:8
    ds_read_b64_tr_b16 a[138:139], v1 offset:264
    ds_read_b64_tr_b16 a[140:141], v1 offset:2056
    ds_read_b64_tr_b16 a[142:143], v1 offset:2312
    s_waitcnt vmcnt(24)
    ds_read_b64_tr_b16 a[144:145], v1 offset:4096
    ds_read_b64_tr_b16 a[146:147], v1 offset:4352
    ds_read_b64_tr_b16 a[148:149], v1 offset:6144
    ds_read_b64_tr_b16 a[150:151], v1 offset:6400
    ds_read_b64_tr_b16 a[152:153], v1 offset:4104
    ds_read_b64_tr_b16 a[154:155], v1 offset:4360
    ds_read_b64_tr_b16 a[156:157], v1 offset:6152
    ds_read_b64_tr_b16 a[158:159], v1 offset:6408
    s_waitcnt vmcnt(20)
    ds_read_b64_tr_b16 a[160:161], v1 offset:8192
    ds_read_b64_tr_b16 a[162:163], v1 offset:8448
    ds_read_b64_tr_b16 a[164:165], v1 offset:10240
    ds_read_b64_tr_b16 a[166:167], v1 offset:10496
    ds_read_b64_tr_b16 a[168:169], v1 offset:8200
    ds_read_b64_tr_b16 a[170:171], v1 offset:8456
    ds_read_b64_tr_b16 a[172:173], v1 offset:10248
    ds_read_b64_tr_b16 a[174:175], v1 offset:10504
    s_waitcnt vmcnt(16)
    ds_read_b64_tr_b16 a[176:177], v1 offset:12288
    ds_read_b64_tr_b16 a[178:179], v1 offset:12544
    ds_read_b64_tr_b16 a[180:181], v1 offset:14336
    ds_read_b64_tr_b16 a[182:183], v1 offset:14592
    ds_read_b64_tr_b16 a[184:185], v1 offset:12296
    ds_read_b64_tr_b16 a[186:187], v1 offset:12552
    ds_read_b64_tr_b16 a[188:189], v1 offset:14344
    ds_read_b64_tr_b16 a[190:191], v1 offset:14600
    s_waitcnt vmcnt(12)
    ds_read_b64_tr_b16 a[192:193], v1 offset:16384
    ds_read_b64_tr_b16 a[194:195], v1 offset:16640
    ds_read_b64_tr_b16 a[196:197], v1 offset:18432
    ds_read_b64_tr_b16 a[198:199], v1 offset:18688
    ds_read_b64_tr_b16 a[200:201], v1 offset:16392
    ds_read_b64_tr_b16 a[202:203], v1 offset:16648
    ds_read_b64_tr_b16 a[204:205], v1 offset:18440
    ds_read_b64_tr_b16 a[206:207], v1 offset:18696
    s_waitcnt vmcnt(8)
    ds_read_b64_tr_b16 a[208:209], v1 offset:20480
    ds_read_b64_tr_b16 a[210:211], v1 offset:20736
    ds_read_b64_tr_b16 a[212:213], v1 offset:22528
    ds_read_b64_tr_b16 a[214:215], v1 offset:22784
    ds_read_b64_tr_b16 a[216:217], v1 offset:20488
    ds_read_b64_tr_b16 a[218:219], v1 offset:20744
    ds_read_b64_tr_b16 a[220:221], v1 offset:22536
    ds_read_b64_tr_b16 a[222:223], v1 offset:22792
    s_waitcnt vmcnt(4)
    ds_read_b64_tr_b16 a[224:225], v1 offset:24576
    ds_read_b64_tr_b16 a[226:227], v1 offset:24832
    ds_read_b64_tr_b16 a[228:229], v1 offset:26624
    ds_read_b64_tr_b16 a[230:231], v1 offset:26880
    ds_read_b64_tr_b16 a[232:233], v1 offset:24584
    ds_read_b64_tr_b16 a[234:235], v1 offset:24840
    ds_read_b64_tr_b16 a[236:237], v1 offset:26632
    ds_read_b64_tr_b16 a[238:239], v1 offset:26888
    s_waitcnt vmcnt(0)
    ds_read_b64_tr_b16 a[240:241], v1 offset:28672
    ds_read_b64_tr_b16 a[242:243], v1 offset:28928
    ds_read_b64_tr_b16 a[244:245], v1 offset:30720
    ds_read_b64_tr_b16 a[246:247], v1 offset:30976
    ds_read_b64_tr_b16 a[248:249], v1 offset:28680
    ds_read_b64_tr_b16 a[250:251], v1 offset:28936
    ds_read_b64_tr_b16 a[252:253], v1 offset:30728
    ds_read_b64_tr_b16 a[254:255], v1 offset:30984
    s_waitcnt lgkmcnt(0)
    s_mov_b32 s59, 40000
    s_cmp_lg_u32 s58, 0
    s_cselect_b32 s59, 1, s59
.spin15:
    s_waitcnt vmcnt(0)
    v_cmp_eq_u32 vcc, 1, v127
    s_cmp_lg_u32 s64, 0
    s_cbranch_scc1 .spinx16
    s_cbranch_vccnz .spinx16
    buffer_load_dword v127, off, s[52:55], s69 sc1
    s_sub_u32 s59, s59, 1
    s_cmp_lg_u32 s59, 0
    s_cbranch_scc1 .spin15
    s_mov_b32 s58, 1
.spinx16:
    s_waitcnt vmcnt(0)
    s_barrier
    s_mov_b32 s74, -1
    s_and_b32 s72, s56, 1
    s_lshr_b32 s73, s56, 1
    v_bfe_u32 v10, v0, 6, 2
    v_lshlrev_b32 v10, 3, v10
    v_bfe_u32 v11, v0, 4, 2
    v_add_u32 v10, v10, v11
    s_lshl_b32 s3, s72, 2
    v_add_u32 v12, s3, v10
    v_lshrrev_b32 v11, 5, v0
    v_and_b32 v11, 0x18, v11
    v_sub_u32 v12, v12, v11
    v_mov_b32 v13, 0xf149f2ca
    v_cmp_le_i32 vcc, 0, v12
    s_nop 1
    v_cndmask_b32 v80, v13, 0, vcc
    v_cmp_le_i32 vcc, 1, v12
    s_nop 1
    v_cndmask_b32 v81, v13, 0, vcc
    v_cmp_le_i32 vcc, 2, v12
    s_nop 1
    v_cndmask_b32 v82, v13, 0, vcc
    v_cmp_le_i32 vcc, 3, v12
    s_nop 1
    v_cndmask_b32 v83, v13, 0, vcc
    v_cmp_le_i32 vcc, 4, v12
    s_nop 1
    v_cndmask_b32 v84, v13, 0, vcc
    v_cmp_le_i32 vcc, 5, v12
    s_nop 1
    v_cndmask_b32 v85, v13, 0, vcc
    v_cmp_le_i32 vcc, 6, v12
    s_nop 1
    v_cndmask_b32 v86, v13, 0, vcc
    v_cmp_le_i32 vcc, 7, v12
    s_nop 1
    v_cndmask_b32 v87, v13, 0, vcc
    v_bfe_u32 v12, v0, 4, 1
    v_lshlrev_b32 v12, 4, v12
    v_mov_b32 v13, 0x3f80
    v_lshlrev_b32 v13, v12, v13
    v_bfe_u32 v12, v0, 5, 2
    v_cmp_eq_u32 vcc, 0, v12
    s_nop 1
    v_cndmask_b32 v88, 0, v13, vcc
    v_cmp_eq_u32 vcc, 1, v12
    s_nop 1
    v_cndmask_b32 v89, 0, v13, vcc
    v_cmp_eq_u32 vcc, 2, v12
    s_nop 1
    v_cndmask_b32 v90, 0, v13, vcc
    v_cmp_eq_u32 vcc, 3, v12
    s_nop 1
    v_cndmask_b32 v91, 0, v13, vcc
    v_and_b32 v12, 0x300, v0
    v_and_b32 v13, 0xf0, v0
    v_lshl_or_b32 v6, v12, 2, v13
    s_lshl_b32 s3, s56, 8
    v_add_u32 v6, s3, v6
    v_mov_b32 v13, 0x200
    v_cmp_gt_u32 vcc, v13, v0
    v_mov_b32 v14, 1072693248
    s_nop 0
    v_cndmask_b32 v7, v14, v6, vcc
    s_and_b32 s3, s63, 1
    s_lshl_b32 s3, s3, 2
    v_add_u32 v10, s3, v10
    v_lshlrev_b32 v10, 10, v10
    v_lshrrev_b32 v12, 5, v12
    s_lshr_b32 s3, s63, 1
    s_lshl_b32 s3, s3, 6
    s_lshl_b32 s4, s56, 4
    s_add_u32 s3, s3, s4
    v_add3_u32 v10, v10, v12, s3
    v_cndmask_b32 v8, v14, v10, vcc
    v_lshrrev_b32 v9, 2, v0
    v_mov_b32 v93, 0
    v_mov_b32 v94, 0
    v_mov_b32 v14, 0x4444
    v_mov_b32 v15, 0xeeee
    v_and_b32 v13, 0x20, v0
    v_cmp_eq_u32 vcc, 0, v13
    s_nop 1
    v_cndmask_b32 v1, v15, v14, vcc
    v_and_b32 v13, 0xf0, v0
    v_lshlrev_b32 v13, 1, v13
    v_bfe_u32 v14, v0, 8, 2
    v_lshl_or_b32 v13, v14, 3, v13
    s_lshl_b32 s3, s56, 9
    v_add_u32 v2, s3, v13
    s_lshl_b32 s3, s72, 12
    s_lshl_b32 s4, s73, 11
    s_add_u32 s3, s3, s4
    v_add_u32 v5, s3, v4
    s_mov_b32 s65, s64
.att17:
    s_mul_i32 s3, s63, 24576
    s_mul_i32 s4, s65, 786432
    s_add_u32 s3, s3, s4
    s_add_u32 s3, s3, 2097152
    s_lshl_b32 s4, s72, 12
    s_add_u32 s4, s4, s3
    s_add_u32 s4, s4, 16384
    buffer_load_dwordx4 v[16:19], v0, s[52:55], s4 offen offset:0 sc1
    buffer_load_dwordx4 v[20:23], v0, s[52:55], s4 offen offset:1024 sc1
    buffer_load_dwordx4 v[24:27], v0, s[52:55], s4 offen offset:2048 sc1
    buffer_load_dwordx4 v[28:31], v0, s[52:55], s4 offen offset:3072 sc1
    s_add_u32 s4, s3, 4096
    buffer_load_dwordx4 v[48:51], v0, s[52:55], s3 offen offset:0 sc1
    buffer_load_dwordx4 v[52:55], v0, s[52:55], s3 offen offset:1024 sc1
    buffer_load_dwordx4 v[56:59], v0, s[52:55], s3 offen offset:2048 sc1
    buffer_load_dwordx4 v[60:63], v0, s[52:55], s3 offen offset:3072 sc1
    buffer_load_dwordx4 v[64:67], v0, s[52:55], s4 offen offset:0 sc1
    buffer_load_dwordx4 v[68:71], v0, s[52:55], s4 offen offset:1024 sc1
    buffer_load_dwordx4 v[72:75], v0, s[52:55], s4 offen offset:2048 sc1
    buffer_load_dwordx4 v[76:79], v0, s[52:55], s4 offen offset:3072 sc1
    s_lshl_b32 s4, s73, 12
    s_add_u32 s4, s4, s3
    s_add_u32 s4, s4, 8192
    buffer_load_dwordx4 v[32:35], v0, s[52:55], s4 offen offset:0 sc1
    buffer_load_dwordx4 v[36:39], v0, s[52:55], s4 offen offset:1024 sc1
    buffer_load_dwordx4 v[40:43], v0, s[52:55], s4 offen offset:2048 sc1
    buffer_load_dwordx4 v[44:47], v0, s[52:55], s4 offen offset:3072 sc1
    s_lshl_b32 s6, s65, 13
    s_lshl_b32 s3, s56, 11
    s_add_u32 s6, s6, s3
    s_add_u32 s6, s6, 69206016
    buffer_load_dwordx4 v[104:107], v0, s[52:55], s6 offen offset:0 sc1
    buffer_load_dwordx4 v[108:111], v0, s[52:55], s6 offen offset:1024 sc1
    v_add_u32 v12, s3, v0
    s_waitcnt vmcnt(6)
    v_mfma_f32_16x16x32_bf16 v[96:99], v[48:51], v[16:19], v[80:83]
    v_mfma_f32_16x16x32_bf16 v[100:103], v[64:67], v[16:19], v[84:87]
    v_mfma_f32_16x16x32_bf16 v[96:99], v[52:55], v[20:23], v[96:99]
    v_mfma_f32_16x16x32_bf16 v[100:103], v[68:71], v[20:23], v[100:103]
    v_mfma_f32_16x16x32_bf16 v[96:99], v[56:59], v[24:27], v[96:99]
    v_mfma_f32_16x16x32_bf16 v[100:103], v[72:75], v[24:27], v[100:103]
    v_mfma_f32_16x16x32_bf16 v[96:99], v[60:63], v[28:31], v[96:99]
    v_mfma_f32_16x16x32_bf16 v[100:103], v[76:79], v[28:31], v[100:103]
    v_mov_b64 v[112:113], 0
    v_mov_b64 v[114:115], 0
    v_mov_b64 v[116:117], 0
    v_mov_b64 v[118:119], 0
    v_mov_b64 v[120:121], 0
    v_mov_b64 v[122:123], 0
    v_mov_b64 v[124:125], 0
    v_mov_b64 v[126:127], 0
    v_max3_f32 v10, v96, v97, v98
    v_max3_f32 v11, v99, v100, v101
    v_max3_f32 v10, v10, v102, v103
    v_max_f32 v10, v10, v11
    s_cmp_lt_u32 s65, 57
    s_cbranch_scc1 .nb19
    s_lshl_b32 s7, s65, 2
    s_lshr_b32 s3, s63, 3
    s_add_u32 s7, s7, s3
    s_lshl_b32 s7, s7, 8
    s_add_u32 s7, s7, 167837696
    s_mov_b32 s59, 40000
    s_cmp_lg_u32 s58, 0
    s_cselect_b32 s59, 1, s59
.spin20:
    buffer_load_dword v11, v9, s[52:55], s7 offen sc1
    s_waitcnt vmcnt(0)
    v_cmp_eq_u32 vcc, 1, v11
    s_and_b32 s5, vcc_hi, 16383
    s_xor_b32 s5, s5, 16383
    s_cbranch_scc0 .spinx21
    s_sub_u32 s59, s59, 1
    s_cmp_lg_u32 s59, 0
    s_cbranch_scc1 .spin20
    s_mov_b32 s58, 1
.spinx21:
    s_lshl_b32 s3, s65, 5
    s_add_u32 s3, s3, s63
    s_mul_i32 s3, s3, 47104
    s_add_u32 s3, s3, 70287360
    buffer_load_dwordx4 v[48:51], v6, s[52:55], s3 offen sc1
    s_add_u32 s3, s3, 4096
    buffer_load_dwordx4 v[52:55], v6, s[52:55], s3 offen sc1
    s_add_u32 s3, s3, 4096
    buffer_load_dwordx4 v[56:59], v6, s[52:55], s3 offen sc1
    s_add_u32 s3, s3, 4096
    buffer_load_dwordx4 v[60:63], v7, s[52:55], s3 offen sc1
    s_lshl_b32 s75, s65, 15
    buffer_load_dwordx2 v[84:85], v8, s[8:11], s75 offen
    s_waitcnt vmcnt(4)
    v_mfma_f32_16x16x32_bf16 v[80:83], v[88:91], v[48:51], 0
    s_waitcnt vmcnt(3)
    v_mfma_f32_16x16x32_bf16 v[80:83], v[88:91], v[52:55], v[80:83]
    s_waitcnt vmcnt(2)
    v_mfma_f32_16x16x32_bf16 v[80:83], v[88:91], v[56:59], v[80:83]
    s_waitcnt vmcnt(1)
    v_mfma_f32_16x16x32_bf16 v[80:83], v[88:91], v[60:63], v[80:83]
.nb19:
    s_waitcnt vmcnt(0)
    v_max3_u32 v11, v104, v105, v106
    v_max3_u32 v13, v109, v110, v111
    v_max3_u32 v11, v11, v107, v108
    v_max_u32 v11, v11, v13
    v_cmp_eq_u32 vcc, -1, v11
    s_cbranch_vccz .got18
    s_sub_i32 s7, s65, 1
    s_max_i32 s7, s7, 0
    s_lshl_b32 s7, s7, 5
    s_add_u32 s7, s7, s63
    s_lshl_b32 s7, s7, 2
    s_add_u32 s7, s7, s56
    s_lshl_b32 s7, s7, 6
    s_add_u32 s7, s7, 69206016
    s_mov_b64 exec, 1
    s_mov_b32 s59, 40000
    s_cmp_lg_u32 s58, 0
    s_cselect_b32 s59, 1, s59
.spin23:
    buffer_load_dword v11, off, s[52:55], s7 sc1
    s_waitcnt vmcnt(0)
    v_cmp_eq_u32 vcc, -1, v11
    s_cbranch_vccz .spinx24
    s_sub_u32 s59, s59, 1
    s_cmp_lg_u32 s59, 0
    s_cbranch_scc1 .spin23
    s_mov_b32 s58, 1
.spinx24:
    s_mov_b64 exec, -1
    s_mov_b32 s59, 40000
    s_cmp_lg_u32 s58, 0
    s_cselect_b32 s59, 1, s59
.spin25:
    buffer_load_dwordx4 v[104:107], v0, s[52:55], s6 offen offset:0 sc1
    buffer_load_dwordx4 v[108:111], v0, s[52:55], s6 offen offset:1024 sc1
    s_waitcnt vmcnt(0)
    v_max3_u32 v11, v104, v105, v106
    v_max3_u32 v13, v109, v110, v111
    v_max3_u32 v11, v11, v107, v108
    v_max_u32 v11, v11, v13
    v_cmp_eq_u32 vcc, -1, v11
    s_cbranch_vccz .spinx26
    s_sub_u32 s59, s59, 1
    s_cmp_lg_u32 s59, 0
    s_cbranch_scc1 .spin25
    s_mov_b32 s58, 1
.spinx26:
.got18:
    ds_write_b128 v12, v[104:107] offset:0
    ds_write_b128 v12, v[108:111] offset:1024
    s_sub_u32 s3, s65, 50
    s_cmp_lt_u32 s3, 7
    s_cbranch_scc0 .npz27
    v_mov_b64 v[76:77], -1
    v_mov_b64 v[78:79], -1
    s_lshl_b32 s3, s65, 2
    s_add_u32 s3, s3, s56
    s_mul_i32 s3, s3, 368
    s_add_u32 s3, s3, s63
    s_lshl_b32 s3, s3, 10
    s_add_u32 s3, s3, 80805888
    buffer_store_dwordx4 v[76:79], v0, s[52:55], s3 offen sc1
    s_add_u32 s3, s3, 47104
    buffer_store_dwordx4 v[76:79], v0, s[52:55], s3 offen sc1
    s_add_u32 s3, s3, 47104
    buffer_store_dwordx4 v[76:79], v0, s[52:55], s3 offen sc1
    s_add_u32 s3, s3, 47104
    buffer_store_dwordx4 v[76:79], v0, s[52:55], s3 offen sc1
    s_add_u32 s3, s3, 47104
    buffer_store_dwordx4 v[76:79], v0, s[52:55], s3 offen sc1
    s_add_u32 s3, s3, 47104
    buffer_store_dwordx4 v[76:79], v0, s[52:55], s3 offen sc1
    s_add_u32 s3, s3, 47104
    buffer_store_dwordx4 v[76:79], v0, s[52:55], s3 offen sc1
    s_add_u32 s3, s3, 47104
    buffer_store_dwordx4 v[76:79], v0, s[52:55], s3 offen sc1
.npz27:
    v_xor_b32 v13, 12, v2
    v_lshrrev_b32 v12, 1, v0
    s_waitcnt lgkmcnt(0)
    s_barrier
    ds_read_b128 v[48:51], v0 offset:0
    ds_read_b128 v[52:55], v0 offset:1024
    ds_read_b128 v[56:59], v0 offset:2048
    ds_read_b128 v[60:63], v0 offset:3072
    ds_read_b128 v[64:67], v0 offset:4096
    ds_read_b128 v[68:71], v0 offset:5120
    ds_read_b128 v[72:75], v0 offset:6144
    ds_read_b128 v[76:79], v0 offset:7168
    s_waitcnt lgkmcnt(7)
    v_smfmac_f32_16x16x64_bf16 v[112:115], v[48:51], v[128:135], v1
    v_smfmac_f32_16x16x64_bf16 v[116:119], v[48:51], v[136:143], v1
    s_waitcnt lgkmcnt(6)
    v_smfmac_f32_16x16x64_bf16 v[112:115], v[52:55], v[144:151], v1
    v_smfmac_f32_16x16x64_bf16 v[116:119], v[52:55], v[152:159], v1
    s_waitcnt lgkmcnt(5)
    v_smfmac_f32_16x16x64_bf16 v[112:115], v[56:59], v[160:167], v1
    v_smfmac_f32_16x16x64_bf16 v[116:119], v[56:59], v[168:175], v1
    s_waitcnt lgkmcnt(4)
    v_smfmac_f32_16x16x64_bf16 v[112:115], v[60:63], v[176:183], v1
    v_smfmac_f32_16x16x64_bf16 v[116:119], v[60:63], v[184:191], v1
    s_waitcnt lgkmcnt(3)
    v_smfmac_f32_16x16x64_bf16 v[112:115], v[64:67], v[192:199], v1
    v_smfmac_f32_16x16x64_bf16 v[116:119], v[64:67], v[200:207], v1
    s_waitcnt lgkmcnt(2)
    v_smfmac_f32_16x16x64_bf16 v[112:115], v[68:71], v[208:215], v1
    v_smfmac_f32_16x16x64_bf16 v[116:119], v[68:71], v[216:223], v1
    s_waitcnt lgkmcnt(1)
    v_smfmac_f32_16x16x64_bf16 v[112:115], v[72:75], v[224:231], v1
    v_smfmac_f32_16x16x64_bf16 v[116:119], v[72:75], v[232:239], v1
    s_waitcnt lgkmcnt(0)
    v_smfmac_f32_16x16x64_bf16 v[112:115], v[76:79], v[240:247], v1
    v_smfmac_f32_16x16x64_bf16 v[116:119], v[76:79], v[248:255], v1
    v_smfmac_f32_16x16x64_bf16 v[120:123], v[48:51], a[0:7], v1
    v_smfmac_f32_16x16x64_bf16 v[124:127], v[48:51], a[8:15], v1
    v_add_f32 v112, v112, v114
    v_smfmac_f32_16x16x64_bf16 v[120:123], v[52:55], a[16:23], v1
    v_add_f32 v113, v113, v115
    v_smfmac_f32_16x16x64_bf16 v[124:127], v[52:55], a[24:31], v1
    v_cvt_pk_bf16_f32 v112, v112, v113
    v_smfmac_f32_16x16x64_bf16 v[120:123], v[56:59], a[32:39], v1
    v_add_f32 v116, v116, v118
    v_smfmac_f32_16x16x64_bf16 v[124:127], v[56:59], a[40:47], v1
    v_add_f32 v117, v117, v119
    v_smfmac_f32_16x16x64_bf16 v[120:123], v[60:63], a[48:55], v1
    v_cvt_pk_bf16_f32 v113, v116, v117
    v_smfmac_f32_16x16x64_bf16 v[124:127], v[60:63], a[56:63], v1
    ds_write2st64_b32 v2, v112, v113 offset0:32 offset1:40
    v_smfmac_f32_16x16x64_bf16 v[120:123], v[64:67], a[64:71], v1
    ds_write2st64_b32 v13, v112, v113 offset0:32 offset1:40
    v_smfmac_f32_16x16x64_bf16 v[124:127], v[64:67], a[72:79], v1
    s_lshl_b32 s3, s56, 9
    v_smfmac_f32_16x16x64_bf16 v[120:123], v[68:71], a[80:87], v1
    v_add_u32 v13, s3, v12
    v_smfmac_f32_16x16x64_bf16 v[124:127], v[68:71], a[88:95], v1
    s_lshl_b32 s3, s73, 10
    v_smfmac_f32_16x16x64_bf16 v[120:123], v[72:75], a[96:103], v1
    v_add_u32 v11, s3, v12
    v_smfmac_f32_16x16x64_bf16 v[124:127], v[72:75], a[104:111], v1
    v_smfmac_f32_16x16x64_bf16 v[120:123], v[76:79], a[112:119], v1
    v_smfmac_f32_16x16x64_bf16 v[124:127], v[76:79], a[120:127], v1
    s_nop 3
    v_add_f32 v120, v120, v122
    v_add_f32 v121, v121, v123
    v_cvt_pk_bf16_f32 v120, v120, v121
    s_nop 0
    v_add_f32 v124, v124, v126
    v_add_f32 v125, v125, v127
    v_cvt_pk_bf16_f32 v121, v124, v125
    ds_write_b64 v13, v[120:121] offset:12288
    s_waitcnt lgkmcnt(0)
    s_barrier
    ds_read_b64_tr_b16 v[48:49], v12 offset:8192
    ds_read_b64_tr_b16 v[50:51], v12 offset:10240
    ds_read_b64_tr_b16 v[52:53], v12 offset:8704
    ds_read_b64_tr_b16 v[54:55], v12 offset:10752
    ds_read_b64_tr_b16 v[56:57], v12 offset:9216
    ds_read_b64_tr_b16 v[58:59], v12 offset:11264
    ds_read_b64_tr_b16 v[60:61], v12 offset:9728
    ds_read_b64_tr_b16 v[62:63], v12 offset:11776
    ds_read_b64 v[64:65], v11 offset:12288
    ds_read_b64 v[66:67], v11 offset:12800
    s_waitcnt lgkmcnt(8)
    v_mfma_f32_16x16x32_bf16 v[104:107], v[48:51], v[16:19], 0
    s_waitcnt lgkmcnt(6)
    v_mfma_f32_16x16x32_bf16 v[104:107], v[52:55], v[20:23], v[104:107]
    s_waitcnt lgkmcnt(4)
    v_mfma_f32_16x16x32_bf16 v[104:107], v[56:59], v[24:27], v[104:107]
    s_waitcnt lgkmcnt(2)
    v_mfma_f32_16x16x32_bf16 v[104:107], v[60:63], v[28:31], v[104:107]
    s_nop 7
    v_max3_f32 v10, v10, v104, v105
    v_mov_b32 v11, v10
    s_nop 1
    v_permlane16_swap_b32 v11, v10
    v_max_f32 v10, v10, v11
    v_mov_b32 v11, v10
    s_nop 1
    v_permlane32_swap_b32 v11, v10
    v_max_f32 v10, v10, v11
    s_mov_b32 s3, 0x3e0293ee
    v_mul_f32 v10, s3, v10
    v_fma_f32 v96, v96, s3, -v10
    v_fma_f32 v97, v97, s3, -v10
    v_fma_f32 v98, v98, s3, -v10
    v_fma_f32 v99, v99, s3, -v10
    v_fma_f32 v100, v100, s3, -v10
    v_fma_f32 v101, v101, s3, -v10
    v_fma_f32 v102, v102, s3, -v10
    v_fma_f32 v103, v103, s3, -v10
    v_fma_f32 v104, v104, s3, -v10
    v_fma_f32 v105, v105, s3, -v10
    v_exp_f32 v96, v96
    v_exp_f32 v97, v97
    v_exp_f32 v98, v98
    v_exp_f32 v99, v99
    v_exp_f32 v100, v100
    v_exp_f32 v101, v101
    v_exp_f32 v102, v102
    v_exp_f32 v103, v103
    v_exp_f32 v104, v104
    v_exp_f32 v105, v105
    v_cvt_pk_bf16_f32 v68, v96, v97
    v_cvt_pk_bf16_f32 v69, v98, v99
    v_cvt_pk_bf16_f32 v70, v100, v101
    v_cvt_pk_bf16_f32 v71, v102, v103
    v_cvt_pk_bf16_f32 v72, v96, v97
    v_cvt_pk_bf16_f32 v73, v98, v99
    v_cvt_pk_bf16_f32 v92, v104, v105
    v_cvt_pk_bf16_f32 v95, v104, v105
    s_waitcnt lgkmcnt(0)
    v_mfma_f32_16x16x32_bf16 v[112:115], v[32:35], v[68:71], 0
    v_mfma_f32_16x16x32_bf16 v[116:119], v[36:39], v[70:73], 0
    v_mfma_f32_16x16x32_bf16 v[120:123], v[40:43], v[68:71], 0
    v_mfma_f32_16x16x32_bf16 v[124:127], v[44:47], v[70:73], 0
    v_mfma_f32_16x16x16_bf16 v[112:115], v[64:65], v[92:93], v[112:115]
    v_mfma_f32_16x16x16_bf16 v[116:119], v[64:65], v[94:95], v[116:119]
    v_mfma_f32_16x16x16_bf16 v[120:123], v[66:67], v[92:93], v[120:123]
    v_mfma_f32_16x16x16_bf16 v[124:127], v[66:67], v[94:95], v[124:127]
    v_add_f32 v11, v104, v105
    v_add_f32 v11, v11, v96
    v_add_f32 v11, v11, v97
    v_add_f32 v11, v11, v98
    v_add_f32 v11, v11, v99
    v_add_f32 v11, v11, v100
    v_add_f32 v11, v11, v101
    v_add_f32 v11, v11, v102
    v_add_f32 v11, v11, v103
    v_mov_b32 v12, v11
    s_nop 1
    v_permlane16_swap_b32 v12, v11
    v_add_f32 v11, v11, v12
    v_mov_b32 v12, v11
    s_nop 1
    v_permlane32_swap_b32 v12, v11
    v_add_f32 v11, v11, v12
    v_rcp_f32 v11, v11
    s_nop 0
    v_mul_f32 v112, v112, v11
    v_mul_f32 v113, v113, v11
    v_mul_f32 v114, v114, v11
    v_mul_f32 v115, v115, v11
    v_mul_f32 v116, v116, v11
    v_mul_f32 v117, v117, v11
    v_mul_f32 v118, v118, v11
    v_mul_f32 v119, v119, v11
    v_mul_f32 v120, v120, v11
    v_mul_f32 v121, v121, v11
    v_mul_f32 v122, v122, v11
    v_mul_f32 v123, v123, v11
    v_mul_f32 v124, v124, v11
    v_mul_f32 v125, v125, v11
    v_mul_f32 v126, v126, v11
    v_mul_f32 v127, v127, v11
    v_cvt_pk_bf16_f32 v96, v112, v113
    v_cvt_pk_bf16_f32 v97, v114, v115
    v_cvt_pk_bf16_f32 v98, v116, v117
    v_cvt_pk_bf16_f32 v99, v118, v119
    ds_write_b128 v5, v[96:99] offset:0
    v_cvt_pk_bf16_f32 v100, v120, v121
    v_cvt_pk_bf16_f32 v101, v122, v123
    v_cvt_pk_bf16_f32 v102, v124, v125
    v_cvt_pk_bf16_f32 v103, v126, v127
    ds_write_b128 v5, v[100:103] offset:1024
    s_lshl_b32 s3, s65, 2
    s_add_u32 s3, s3, s56
    s_lshl_b32 s68, s3, 6
    s_add_u32 s68, s68, s63
    s_lshl_b32 s68, s68, 2
    s_add_u32 s68, s68, 167837696
    s_mul_i32 s3, s3, 368
    s_add_u32 s3, s3, s63
    s_lshl_b32 s3, s3, 10
    s_add_u32 s69, s3, 70254592
    s_waitcnt lgkmcnt(0)
    s_barrier
    s_add_u32 s5, s65, 7
    s_mul_i32 s3, s63, 24576
    s_mul_i32 s4, s5, 786432
    s_add_u32 s3, s3, s4
    s_lshl_b32 s4, s56, 13
    s_add_u32 s3, s3, s4
    s_add_u32 s3, s3, 2097152
    s_lshl_b32 s4, s5, 13
    s_add_u32 s4, s4, 69206016
    s_cmp_eq_u32 s56, 3
    s_cselect_b32 s3, s4, s3
    s_cmp_lt_u32 s5, 64
    s_cselect_b32 s3, s3, 1072693248
    v_lshlrev_b32 v10, 3, v0
    buffer_load_dword v11, v10, s[52:55], s3 offen sc1
    ds_read_b128 v[16:19], v4 offset:0
    ds_read_b128 v[32:35], v4 offset:4096
    ds_read_b128 v[20:23], v4 offset:1024
    ds_read_b128 v[36:39], v4 offset:5120
    ds_read_b128 v[24:27], v4 offset:2048
    ds_read_b128 v[40:43], v4 offset:6144
    ds_read_b128 v[28:31], v4 offset:3072
    ds_read_b128 v[44:47], v4 offset:7168
    s_waitcnt lgkmcnt(6)
    v_mfma_f32_16x16x32_bf16 v[48:51], a[128:131], v[16:19], 0
    v_mfma_f32_16x16x32_bf16 v[52:55], a[128:131], v[32:35], 0
    v_mfma_f32_16x16x32_bf16 v[56:59], a[136:139], v[16:19], 0
    v_mfma_f32_16x16x32_bf16 v[60:63], a[136:139], v[32:35], 0
    s_waitcnt lgkmcnt(4)
    v_mfma_f32_16x16x32_bf16 v[48:51], a[132:135], v[20:23], v[48:51]
    v_mfma_f32_16x16x32_bf16 v[52:55], a[132:135], v[36:39], v[52:55]
    v_mfma_f32_16x16x32_bf16 v[56:59], a[140:143], v[20:23], v[56:59]
    v_mfma_f32_16x16x32_bf16 v[60:63], a[140:143], v[36:39], v[60:63]
    s_waitcnt lgkmcnt(2)
    v_mfma_f32_16x16x32_bf16 v[48:51], a[144:147], v[24:27], v[48:51]
    v_mfma_f32_16x16x32_bf16 v[52:55], a[144:147], v[40:43], v[52:55]
    v_mfma_f32_16x16x32_bf16 v[56:59], a[152:155], v[24:27], v[56:59]
    v_mfma_f32_16x16x32_bf16 v[60:63], a[152:155], v[40:43], v[60:63]
    s_waitcnt lgkmcnt(0)
    v_mfma_f32_16x16x32_bf16 v[48:51], a[148:151], v[28:31], v[48:51]
    v_mfma_f32_16x16x32_bf16 v[52:55], a[148:151], v[44:47], v[52:55]
    v_mfma_f32_16x16x32_bf16 v[56:59], a[156:159], v[28:31], v[56:59]
    v_mfma_f32_16x16x32_bf16 v[60:63], a[156:159], v[44:47], v[60:63]
    v_mfma_f32_16x16x32_bf16 v[64:67], a[160:163], v[16:19], 0
    v_mfma_f32_16x16x32_bf16 v[68:71], a[160:163], v[32:35], 0
    v_mfma_f32_16x16x32_bf16 v[72:75], a[168:171], v[16:19], 0
    v_mfma_f32_16x16x32_bf16 v[76:79], a[168:171], v[32:35], 0
    v_mfma_f32_16x16x32_bf16 v[64:67], a[164:167], v[20:23], v[64:67]
    v_mfma_f32_16x16x32_bf16 v[68:71], a[164:167], v[36:39], v[68:71]
    v_mfma_f32_16x16x32_bf16 v[72:75], a[172:175], v[20:23], v[72:75]
    v_mfma_f32_16x16x32_bf16 v[76:79], a[172:175], v[36:39], v[76:79]
    v_cvt_pk_bf16_f32 v96, v48, v49
    v_cvt_pk_bf16_f32 v97, v50, v51
    v_cvt_pk_bf16_f32 v98, v56, v57
    v_cvt_pk_bf16_f32 v99, v58, v59
    s_add_u32 s3, s69, 0
    buffer_store_dwordx4 v[96:99], v0, s[52:55], s3 offen sc1
    v_cvt_pk_bf16_f32 v100, v52, v53
    v_cvt_pk_bf16_f32 v101, v54, v55
    v_cvt_pk_bf16_f32 v102, v60, v61
    v_cvt_pk_bf16_f32 v103, v62, v63
    s_add_u32 s3, s69, 47104
    buffer_store_dwordx4 v[100:103], v0, s[52:55], s3 offen sc1
    v_mfma_f32_16x16x32_bf16 v[64:67], a[176:179], v[24:27], v[64:67]
    v_mfma_f32_16x16x32_bf16 v[68:71], a[176:179], v[40:43], v[68:71]
    v_mfma_f32_16x16x32_bf16 v[72:75], a[184:187], v[24:27], v[72:75]
    v_mfma_f32_16x16x32_bf16 v[76:79], a[184:187], v[40:43], v[76:79]
    v_mfma_f32_16x16x32_bf16 v[64:67], a[180:183], v[28:31], v[64:67]
    v_mfma_f32_16x16x32_bf16 v[68:71], a[180:183], v[44:47], v[68:71]
    v_mfma_f32_16x16x32_bf16 v[72:75], a[188:191], v[28:31], v[72:75]
    v_mfma_f32_16x16x32_bf16 v[76:79], a[188:191], v[44:47], v[76:79]
    v_mfma_f32_16x16x32_bf16 v[48:51], a[192:195], v[16:19], 0
    v_mfma_f32_16x16x32_bf16 v[52:55], a[192:195], v[32:35], 0
    v_mfma_f32_16x16x32_bf16 v[56:59], a[200:203], v[16:19], 0
    v_mfma_f32_16x16x32_bf16 v[60:63], a[200:203], v[32:35], 0
    v_mfma_f32_16x16x32_bf16 v[48:51], a[196:199], v[20:23], v[48:51]
    v_mfma_f32_16x16x32_bf16 v[52:55], a[196:199], v[36:39], v[52:55]
    v_mfma_f32_16x16x32_bf16 v[56:59], a[204:207], v[20:23], v[56:59]
    v_mfma_f32_16x16x32_bf16 v[60:63], a[204:207], v[36:39], v[60:63]
    v_cvt_pk_bf16_f32 v104, v64, v65
    v_cvt_pk_bf16_f32 v105, v66, v67
    v_cvt_pk_bf16_f32 v106, v72, v73
    v_cvt_pk_bf16_f32 v107, v74, v75
    s_add_u32 s3, s69, 94208
    buffer_store_dwordx4 v[104:107], v0, s[52:55], s3 offen sc1
    v_cvt_pk_bf16_f32 v108, v68, v69
    v_cvt_pk_bf16_f32 v109, v70, v71
    v_cvt_pk_bf16_f32 v110, v76, v77
    v_cvt_pk_bf16_f32 v111, v78, v79
    s_add_u32 s3, s69, 141312
    buffer_store_dwordx4 v[108:111], v0, s[52:55], s3 offen sc1
    v_mfma_f32_16x16x32_bf16 v[48:51], a[208:211], v[24:27], v[48:51]
    v_mfma_f32_16x16x32_bf16 v[52:55], a[208:211], v[40:43], v[52:55]
    v_mfma_f32_16x16x32_bf16 v[56:59], a[216:219], v[24:27], v[56:59]
    v_mfma_f32_16x16x32_bf16 v[60:63], a[216:219], v[40:43], v[60:63]
    v_mfma_f32_16x16x32_bf16 v[48:51], a[212:215], v[28:31], v[48:51]
    v_mfma_f32_16x16x32_bf16 v[52:55], a[212:215], v[44:47], v[52:55]
    v_mfma_f32_16x16x32_bf16 v[56:59], a[220:223], v[28:31], v[56:59]
    v_mfma_f32_16x16x32_bf16 v[60:63], a[220:223], v[44:47], v[60:63]
    v_mfma_f32_16x16x32_bf16 v[64:67], a[224:227], v[16:19], 0
    v_mfma_f32_16x16x32_bf16 v[68:71], a[224:227], v[32:35], 0
    v_mfma_f32_16x16x32_bf16 v[72:75], a[232:235], v[16:19], 0
    v_mfma_f32_16x16x32_bf16 v[76:79], a[232:235], v[32:35], 0
    v_mfma_f32_16x16x32_bf16 v[64:67], a[228:231], v[20:23], v[64:67]
    v_mfma_f32_16x16x32_bf16 v[68:71], a[228:231], v[36:39], v[68:71]
    v_mfma_f32_16x16x32_bf16 v[72:75], a[236:239], v[20:23], v[72:75]
    v_mfma_f32_16x16x32_bf16 v[76:79], a[236:239], v[36:39], v[76:79]
    v_cvt_pk_bf16_f32 v96, v48, v49
    v_cvt_pk_bf16_f32 v97, v50, v51
    v_cvt_pk_bf16_f32 v98, v56, v57
    v_cvt_pk_bf16_f32 v99, v58, v59
    s_add_u32 s3, s69, 188416
    buffer_store_dwordx4 v[96:99], v0, s[52:55], s3 offen sc1
    v_cvt_pk_bf16_f32 v100, v52, v53
    v_cvt_pk_bf16_f32 v101, v54, v55
    v_cvt_pk_bf16_f32 v102, v60, v61
    v_cvt_pk_bf16_f32 v103, v62, v63
    s_add_u32 s3, s69, 235520
    buffer_store_dwordx4 v[100:103], v0, s[52:55], s3 offen sc1
    v_mfma_f32_16x16x32_bf16 v[64:67], a[240:243], v[24:27], v[64:67]
    v_mfma_f32_16x16x32_bf16 v[68:71], a[240:243], v[40:43], v[68:71]
    v_mfma_f32_16x16x32_bf16 v[72:75], a[248:251], v[24:27], v[72:75]
    v_mfma_f32_16x16x32_bf16 v[76:79], a[248:251], v[40:43], v[76:79]
    v_mfma_f32_16x16x32_bf16 v[64:67], a[244:247], v[28:31], v[64:67]
    v_mfma_f32_16x16x32_bf16 v[68:71], a[244:247], v[44:47], v[68:71]
    v_mfma_f32_16x16x32_bf16 v[72:75], a[252:255], v[28:31], v[72:75]
    v_mfma_f32_16x16x32_bf16 v[76:79], a[252:255], v[44:47], v[76:79]
    v_cvt_pk_bf16_f32 v104, v64, v65
    v_cvt_pk_bf16_f32 v105, v66, v67
    s_nop 0
    v_cvt_pk_bf16_f32 v106, v72, v73
    v_cvt_pk_bf16_f32 v107, v74, v75
    s_add_u32 s3, s69, 282624
    buffer_store_dwordx4 v[104:107], v0, s[52:55], s3 offen sc1
    v_cvt_pk_bf16_f32 v108, v68, v69
    v_cvt_pk_bf16_f32 v109, v70, v71
    v_cvt_pk_bf16_f32 v110, v76, v77
    v_cvt_pk_bf16_f32 v111, v78, v79
    s_add_u32 s3, s69, 329728
    buffer_store_dwordx4 v[108:111], v0, s[52:55], s3 offen sc1
    s_cmp_gt_u32 s65, 56
    s_cbranch_scc1 .Lfin
    s_lshl_b32 s75, s65, 15
    buffer_load_dwordx2 v[14:15], v8, s[8:11], s75 offen
    s_mov_b32 s74, s65
    s_waitcnt vmcnt(1)
    s_mov_b64 exec, 1
    buffer_store_dword v3, off, s[52:55], s68 sc1
    s_mov_b64 exec, -1
    s_barrier
    s_lshl_b32 s7, s74, 2
    s_lshr_b32 s3, s63, 3
    s_add_u32 s7, s7, s3
    s_lshl_b32 s7, s7, 8
    s_add_u32 s7, s7, 167837696
    s_mov_b32 s59, 40000
    s_cmp_lg_u32 s58, 0
    s_cselect_b32 s59, 1, s59
.spin31:
    buffer_load_dword v11, v9, s[52:55], s7 offen sc1
    s_waitcnt vmcnt(0)
    v_cmp_eq_u32 vcc, 1, v11
    s_and_b32 s5, vcc_hi, 16383
    s_xor_b32 s5, s5, 16383
    s_not_b32 s4, vcc_lo
    s_or_b32 s4, s4, s5
    s_cbranch_scc0 .spinx32
    s_sub_u32 s59, s59, 1
    s_cmp_lg_u32 s59, 0
    s_cbranch_scc1 .spin31
    s_mov_b32 s58, 1
.spinx32:
    s_lshl_b32 s3, s74, 5
    s_add_u32 s3, s3, s63
    s_mul_i32 s3, s3, 47104
    s_add_u32 s3, s3, 70254592
    buffer_load_dwordx4 v[16:19], v6, s[52:55], s3 offen sc1
    s_add_u32 s3, s3, 4096
    buffer_load_dwordx4 v[20:23], v6, s[52:55], s3 offen sc1
    s_add_u32 s3, s3, 4096
    buffer_load_dwordx4 v[24:27], v6, s[52:55], s3 offen sc1
    s_add_u32 s3, s3, 4096
    buffer_load_dwordx4 v[28:31], v6, s[52:55], s3 offen sc1
    s_add_u32 s3, s3, 4096
    buffer_load_dwordx4 v[32:35], v6, s[52:55], s3 offen sc1
    s_add_u32 s3, s3, 4096
    buffer_load_dwordx4 v[36:39], v6, s[52:55], s3 offen sc1
    s_add_u32 s3, s3, 4096
    buffer_load_dwordx4 v[40:43], v6, s[52:55], s3 offen sc1
    s_add_u32 s3, s3, 4096
    buffer_load_dwordx4 v[44:47], v6, s[52:55], s3 offen sc1
    s_add_u32 s3, s3, 4096
    buffer_load_dwordx4 v[48:51], v6, s[52:55], s3 offen sc1
    s_add_u32 s3, s3, 4096
    buffer_load_dwordx4 v[52:55], v6, s[52:55], s3 offen sc1
    s_add_u32 s3, s3, 4096
    buffer_load_dwordx4 v[56:59], v6, s[52:55], s3 offen sc1
    s_add_u32 s3, s3, 4096
    buffer_load_dwordx4 v[60:63], v7, s[52:55], s3 offen sc1
    s_waitcnt vmcnt(11)
    v_mfma_f32_16x16x32_bf16 v[64:67], v[88:91], v[16:19], 0
    s_waitcnt vmcnt(10)
    v_mfma_f32_16x16x32_bf16 v[64:67], v[88:91], v[20:23], v[64:67]
    s_waitcnt vmcnt(9)
    v_mfma_f32_16x16x32_bf16 v[64:67], v[88:91], v[24:27], v[64:67]
    s_waitcnt vmcnt(8)
    v_mfma_f32_16x16x32_bf16 v[64:67], v[88:91], v[28:31], v[64:67]
    s_waitcnt vmcnt(7)
    v_mfma_f32_16x16x32_bf16 v[64:67], v[88:91], v[32:35], v[64:67]
    s_waitcnt vmcnt(6)
    v_mfma_f32_16x16x32_bf16 v[64:67], v[88:91], v[36:39], v[64:67]
    s_waitcnt vmcnt(5)
    v_mfma_f32_16x16x32_bf16 v[64:67], v[88:91], v[40:43], v[64:67]
    s_waitcnt vmcnt(4)
    v_mfma_f32_16x16x32_bf16 v[64:67], v[88:91], v[44:47], v[64:67]
    s_waitcnt vmcnt(3)
    v_mfma_f32_16x16x32_bf16 v[68:71], v[88:91], v[48:51], 0
    s_waitcnt vmcnt(2)
    v_mfma_f32_16x16x32_bf16 v[68:71], v[88:91], v[52:55], v[68:71]
    s_waitcnt vmcnt(1)
    v_mfma_f32_16x16x32_bf16 v[68:71], v[88:91], v[56:59], v[68:71]
    s_waitcnt vmcnt(0)
    v_mfma_f32_16x16x32_bf16 v[68:71], v[88:91], v[60:63], v[68:71]
    s_mov_b32 s6, 0xffff0000
    v_lshlrev_b32 v72, 16, v14
    v_and_b32 v73, s6, v14
    v_lshlrev_b32 v74, 16, v15
    v_and_b32 v75, s6, v15
    v_cvt_pk_bf16_f32 v10, v64, v65
    v_cvt_pk_bf16_f32 v11, v66, v67
    v_lshlrev_b32 v64, 16, v10
    v_and_b32 v65, s6, v10
    v_lshlrev_b32 v66, 16, v11
    v_and_b32 v67, s6, v11
    v_add_f32 v72, v72, v64
    v_add_f32 v73, v73, v65
    v_add_f32 v74, v74, v66
    v_add_f32 v75, v75, v67
    v_cvt_pk_bf16_f32 v10, v72, v73
    v_cvt_pk_bf16_f32 v11, v74, v75
    v_lshlrev_b32 v72, 16, v10
    v_and_b32 v73, s6, v10
    v_lshlrev_b32 v74, 16, v11
    v_and_b32 v75, s6, v11
    v_cvt_pk_bf16_f32 v12, v68, v69
    v_cvt_pk_bf16_f32 v13, v70, v71
    v_lshlrev_b32 v68, 16, v12
    v_and_b32 v69, s6, v12
    v_lshlrev_b32 v70, 16, v13
    v_and_b32 v71, s6, v13
    v_add_f32 v72, v72, v68
    v_add_f32 v73, v73, v69
    v_add_f32 v74, v74, v70
    v_add_f32 v75, v75, v71
    v_cvt_pk_bf16_f32 v10, v72, v73
    v_cvt_pk_bf16_f32 v11, v74, v75
    buffer_store_dwordx2 v[10:11], v8, s[44:47], s75 offen
    s_add_u32 s65, s65, 7
    s_cmp_lt_u32 s65, 64
    s_cbranch_scc1 .att17
    s_branch .Lend
.Lfin:
    s_lshl_b32 s3, s65, 5
    s_add_u32 s3, s3, s63
    s_mul_i32 s3, s3, 47104
    s_add_u32 s3, s3, 70254592
    s_mov_b32 s7, s3
    s_waitcnt vmcnt(2)
    s_mov_b32 s59, 40000
    s_cmp_lg_u32 s58, 0
    s_cselect_b32 s59, 1, s59
.spin33:
    s_mov_b32 s3, s7
    buffer_load_dwordx4 v[16:19], v6, s[52:55], s3 offen sc1
    s_add_u32 s3, s3, 4096
    buffer_load_dwordx4 v[20:23], v6, s[52:55], s3 offen sc1
    s_add_u32 s3, s3, 4096
    buffer_load_dwordx4 v[24:27], v6, s[52:55], s3 offen sc1
    s_add_u32 s3, s3, 4096
    buffer_load_dwordx4 v[28:31], v6, s[52:55], s3 offen sc1
    s_add_u32 s3, s3, 4096
    buffer_load_dwordx4 v[32:35], v6, s[52:55], s3 offen sc1
    s_add_u32 s3, s3, 4096
    buffer_load_dwordx4 v[36:39], v6, s[52:55], s3 offen sc1
    s_add_u32 s3, s3, 4096
    buffer_load_dwordx4 v[40:43], v6, s[52:55], s3 offen sc1
    s_add_u32 s3, s3, 4096
    buffer_load_dwordx4 v[44:47], v6, s[52:55], s3 offen sc1
    s_mov_b32 s6, 0xffff0000
    v_lshlrev_b32 v72, 16, v84
    v_and_b32 v73, s6, v84
    v_lshlrev_b32 v74, 16, v85
    v_and_b32 v75, s6, v85
    v_cvt_pk_bf16_f32 v12, v80, v81
    v_cvt_pk_bf16_f32 v13, v82, v83
    v_lshlrev_b32 v80, 16, v12
    v_and_b32 v81, s6, v12
    v_lshlrev_b32 v82, 16, v13
    v_and_b32 v83, s6, v13
    s_waitcnt vmcnt(7)
    v_mfma_f32_16x16x32_bf16 v[64:67], v[88:91], v[16:19], 0
    s_waitcnt vmcnt(6)
    v_mfma_f32_16x16x32_bf16 v[64:67], v[88:91], v[20:23], v[64:67]
    s_waitcnt vmcnt(5)
    v_mfma_f32_16x16x32_bf16 v[64:67], v[88:91], v[24:27], v[64:67]
    s_waitcnt vmcnt(4)
    v_mfma_f32_16x16x32_bf16 v[64:67], v[88:91], v[28:31], v[64:67]
    s_waitcnt vmcnt(3)
    v_mfma_f32_16x16x32_bf16 v[64:67], v[88:91], v[32:35], v[64:67]
    s_waitcnt vmcnt(2)
    v_mfma_f32_16x16x32_bf16 v[64:67], v[88:91], v[36:39], v[64:67]
    s_waitcnt vmcnt(1)
    v_mfma_f32_16x16x32_bf16 v[64:67], v[88:91], v[40:43], v[64:67]
    s_waitcnt vmcnt(0)
    v_mfma_f32_16x16x32_bf16 v[64:67], v[88:91], v[44:47], v[64:67]
    s_nop 7
    v_cmp_u_f32 vcc, v64, v64
    s_cbranch_vccz .spinx34
    v_max_u32 v10, v16, v17
    v_max3_u32 v10, v10, v18, v19
    v_max3_u32 v10, v10, v20, v21
    v_max3_u32 v10, v10, v22, v23
    v_max3_u32 v10, v10, v24, v25
    v_max3_u32 v10, v10, v26, v27
    v_max3_u32 v10, v10, v28, v29
    v_max3_u32 v10, v10, v30, v31
    v_max3_u32 v10, v10, v32, v33
    v_max3_u32 v10, v10, v34, v35
    v_max3_u32 v10, v10, v36, v37
    v_max3_u32 v10, v10, v38, v39
    v_max3_u32 v10, v10, v40, v41
    v_max3_u32 v10, v10, v42, v43
    v_max3_u32 v10, v10, v44, v45
    v_max3_u32 v10, v10, v46, v47
    v_cmp_eq_u32 vcc, -1, v10
    s_cbranch_vccz .spinx34
    s_sub_u32 s59, s59, 1
    s_cmp_lg_u32 s59, 0
    s_cbranch_scc1 .spin33
    s_mov_b32 s58, 1
.spinx34:
    v_cvt_pk_bf16_f32 v10, v64, v65
    v_cvt_pk_bf16_f32 v11, v66, v67
    v_lshlrev_b32 v64, 16, v10
    v_and_b32 v65, s6, v10
    v_lshlrev_b32 v66, 16, v11
    v_and_b32 v67, s6, v11
    v_add_f32 v72, v72, v64
    v_add_f32 v73, v73, v65
    v_add_f32 v74, v74, v66
    v_add_f32 v75, v75, v67
    v_cvt_pk_bf16_f32 v10, v72, v73
    v_cvt_pk_bf16_f32 v11, v74, v75
    v_lshlrev_b32 v72, 16, v10
    v_and_b32 v73, s6, v10
    v_lshlrev_b32 v74, 16, v11
    v_and_b32 v75, s6, v11
    v_add_f32 v72, v72, v80
    v_add_f32 v73, v73, v81
    v_add_f32 v74, v74, v82
    v_add_f32 v75, v75, v83
    v_cvt_pk_bf16_f32 v10, v72, v73
    v_cvt_pk_bf16_f32 v11, v74, v75
    buffer_store_dwordx2 v[10:11], v8, s[44:47], s75 offen
    s_branch .Lend
.Lrec:
    s_cmp_lg_u32 s56, 0
    s_cbranch_scc1 .rf35
    v_mov_b32 v4, 0
    v_mov_b32 v5, 0
    v_lshrrev_b32 v6, 1, v0
    s_lshl_b32 s3, s57, 9
    s_add_u32 s3, s3, 167772160
    buffer_store_dwordx2 v[4:5], v6, s[52:55], s3 offen sc1
    v_mov_b32 v8, -1
    v_mov_b32 v9, -1
    v_mov_b32 v10, -1
    v_mov_b32 v11, -1
    s_lshl_b32 s3, s57, 11
    s_add_u32 s3, s3, 69206016
    buffer_store_dwordx4 v[8:11], v0, s[52:55], s3 offen offset:0 sc1
    buffer_store_dwordx4 v[8:11], v0, s[52:55], s3 offen offset:1024 sc1
.rf35:
    s_mov_b32 s62, s57
    s_mul_i32 s61, s56, 28672
    s_add_u32 s61, s61, 49152
    v_bfe_u32 v16, v0, 4, 1
    v_lshrrev_b32 v5, 2, v0
    v_bfe_u32 v17, v0, 6, 2
    v_bfe_u32 v18, v0, 8, 2
    v_bfe_u32 v19, v0, 5, 1
    v_lshlrev_b32 v20, 4, v16
    v_lshl_or_b32 v20, v19, 6, v20
    v_lshl_or_b32 v20, v17, 2, v20
    v_mov_b32 v21, 1072693248
    v_cmp_eq_u32 vcc, 0, v18
    s_nop 1
    v_cndmask_b32 v6, v21, v20, vcc
    v_mov_b32 v24, -1
    v_mov_b32 v25, -1
    v_mov_b32 v26, -1
    v_mov_b32 v27, -1
    s_and_b32 s3, s62, 6
    s_and_b32 s4, s56, 1
    s_or_b32 s3, s3, s4
    s_lshl_b32 s3, s3, 10
    s_lshr_b32 s4, s62, 3
    s_lshl_b32 s4, s4, 8
    s_add_u32 s3, s3, s4
    s_lshr_b32 s4, s56, 1
    s_lshl_b32 s4, s4, 7
    s_add_u32 s3, s3, s4
    s_and_b32 s4, s62, 1
    s_lshl_b32 s4, s4, 5
    s_add_u32 s3, s3, s4
    s_add_u32 s70, s3, 69206016
    s_add_u32 s84, s3, 168820736
    s_add_u32 s3, s84, 0
    buffer_store_dword v24, v6, s[52:55], s3 offen sc1
    s_add_u32 s3, s84, 8192
    buffer_store_dword v24, v6, s[52:55], s3 offen sc1
    s_add_u32 s3, s84, 16384
    buffer_store_dword v24, v6, s[52:55], s3 offen sc1
    s_add_u32 s3, s84, 24576
    buffer_store_dword v24, v6, s[52:55], s3 offen sc1
    s_lshl_b32 s3, s62, 13
    s_lshl_b32 s4, s56, 11
    s_add_u32 s3, s3, s4
    s_add_u32 s68, s3, 169869312
    buffer_store_dwordx4 v[24:27], v0, s[52:55], s68 offen offset:0 sc1
    buffer_store_dwordx4 v[24:27], v0, s[52:55], s68 offen offset:1024 sc1
    s_cmp_lg_u32 s56, 0
    s_cbranch_scc1 .xm36
    s_mov_b64 exec, 1
    s_lshl_b32 s3, 1, s60
    v_mov_b32 v21, s3
    buffer_atomic_or v21, off, s[48:51], 0 offset:8 sc1
    s_mov_b64 exec, -1
.xm36:
    v_and_b32 v28, 0xf0, v0
    v_and_b32 v30, 0x300, v0
    v_lshlrev_b32 v30, 1, v30
    v_add3_u32 v28, v28, v30, s61
    v_bfe_u32 v30, v0, 7, 1
    v_lshlrev_b32 v30, 9, v30
    v_xor_b32 v29, v30, v28
    v_bfe_u32 v30, v0, 6, 1
    v_lshlrev_b32 v36, 0, v30
    v_bfe_u32 v30, v0, 8, 1
    v_lshl_or_b32 v36, v30, 1, v36
    v_bfe_u32 v30, v0, 9, 1
    v_lshl_or_b32 v36, v30, 2, v36
    s_mov_b32 s3, 1024
    v_mul_lo_u32 v36, v36, s3
    v_bfe_u32 v30, v0, 7, 1
    v_lshl_add_u32 v36, v30, 6, v36
    v_and_b32 v30, 0x30, v0
    s_lshl_b32 s3, s56, 8
    v_add3_u32 v36, v36, v30, s3
    v_add_u32 v37, 7168, v36
    v_add_u32 v38, 14336, v36
    v_add_u32 v39, 21504, v36
    v_bfe_u32 v30, v0, 6, 1
    v_lshlrev_b32 v32, 2, v30
    v_bfe_u32 v30, v0, 7, 1
    v_lshl_or_b32 v32, v30, 3, v32
    v_bfe_u32 v30, v0, 8, 1
    v_lshl_or_b32 v32, v30, 0, v32
    s_mov_b32 s3, 8192
    v_mul_lo_u32 v32, v32, s3
    v_bfe_u32 v30, v0, 9, 1
    v_lshl_add_u32 v32, v30, 6, v32
    v_and_b32 v30, 0x30, v0
    s_lshr_b32 s3, s56, 1
    s_lshl_b32 s3, s3, 7
    v_add3_u32 v32, v32, v30, s3
    v_add_u32 v33, 15360, v32
    v_add_u32 v34, 1046528, v32
    v_add_u32 v35, 1061888, v32
    v_and_b32 v43, 0xf0, v0
    v_and_b32 v30, 0x300, v0
    v_lshl_or_b32 v43, v30, 2, v43
    s_and_b32 s3, s56, 1
    s_lshl_b32 s3, s3, 9
    v_or_b32 v43, s3, v43
    v_add_u32 v7, s61, v0
    s_lshl_b32 s88, s56, 13
    s_add_u32 s88, s88, 16384
    s_sub_u32 s3, s88, s61
    v_add_u32 v31, s3, v28
    v_add_u32 v40, s61, v43
    v_add_u32 v42, s88, v43
    s_xor_b32 s3, s56, 1
    s_mul_i32 s3, s3, 28672
    s_add_u32 s3, s3, 49152
    v_add_u32 v41, s3, v43
    v_xor_b32 v43, 8192, v42
    s_lshl_b32 s80, s62, 8
    s_lshl_b32 s3, s56, 17
    s_add_u32 s80, s80, s3
    s_lshl_b32 s81, s62, 17
    s_add_u32 m0, s61, 12288
    s_xor_b32 s3, s56, 3
    s_lshl_b32 s3, s3, 15
    s_add_u32 s3, s3, s81
    buffer_load_dwordx4 v36, s[28:31], s3 offen offset:0 lds
    buffer_load_dwordx4 v37, s[28:31], s3 offen offset:1024 lds
    buffer_load_dwordx4 v38, s[28:31], s3 offen offset:2048 lds
    buffer_load_dwordx4 v39, s[28:31], s3 offen offset:3072 lds
    s_add_u32 m0, s61, 20480
    s_xor_b32 s3, s56, 0
    s_lshl_b32 s3, s3, 15
    s_add_u32 s3, s3, s81
    buffer_load_dwordx4 v36, s[28:31], s3 offen offset:0 lds
    buffer_load_dwordx4 v37, s[28:31], s3 offen offset:1024 lds
    buffer_load_dwordx4 v38, s[28:31], s3 offen offset:2048 lds
    buffer_load_dwordx4 v39, s[28:31], s3 offen offset:3072 lds
    s_add_u32 m0, s61, 24576
    s_xor_b32 s3, s56, 0
    s_lshl_b32 s3, s3, 15
    s_add_u32 s3, s3, s81
    s_add_u32 s3, s3, 128
    buffer_load_dwordx4 v36, s[28:31], s3 offen offset:0 lds
    buffer_load_dwordx4 v37, s[28:31], s3 offen offset:1024 lds
    buffer_load_dwordx4 v38, s[28:31], s3 offen offset:2048 lds
    buffer_load_dwordx4 v39, s[28:31], s3 offen offset:3072 lds
    s_add_u32 m0, s88, 0
    s_xor_b32 s3, s56, 1
    s_lshl_b32 s3, s3, 15
    s_add_u32 s3, s3, s81
    buffer_load_dwordx4 v36, s[28:31], s3 offen offset:0 lds
    buffer_load_dwordx4 v37, s[28:31], s3 offen offset:1024 lds
    buffer_load_dwordx4 v38, s[28:31], s3 offen offset:2048 lds
    buffer_load_dwordx4 v39, s[28:31], s3 offen offset:3072 lds
    s_add_u32 m0, s88, 4096
    s_xor_b32 s3, s56, 2
    s_lshl_b32 s3, s3, 15
    s_add_u32 s3, s3, s81
    buffer_load_dwordx4 v36, s[28:31], s3 offen offset:0 lds
    buffer_load_dwordx4 v37, s[28:31], s3 offen offset:1024 lds
    buffer_load_dwordx4 v38, s[28:31], s3 offen offset:2048 lds
    buffer_load_dwordx4 v39, s[28:31], s3 offen offset:3072 lds
    s_add_u32 m0, s61, 0
    s_xor_b32 s3, s56, 1
    s_lshl_b32 s3, s3, 15
    s_add_u32 s3, s3, s81
    s_add_u32 s3, s3, 128
    buffer_load_dwordx4 v36, s[28:31], s3 offen offset:0 lds
    buffer_load_dwordx4 v37, s[28:31], s3 offen offset:1024 lds
    buffer_load_dwordx4 v38, s[28:31], s3 offen offset:2048 lds
    buffer_load_dwordx4 v39, s[28:31], s3 offen offset:3072 lds
    s_add_u32 m0, s61, 4096
    s_xor_b32 s3, s56, 2
    s_lshl_b32 s3, s3, 15
    s_add_u32 s3, s3, s81
    s_add_u32 s3, s3, 128
    buffer_load_dwordx4 v36, s[28:31], s3 offen offset:0 lds
    buffer_load_dwordx4 v37, s[28:31], s3 offen offset:1024 lds
    buffer_load_dwordx4 v38, s[28:31], s3 offen offset:2048 lds
    buffer_load_dwordx4 v39, s[28:31], s3 offen offset:3072 lds
    s_add_u32 m0, s61, 8192
    s_xor_b32 s3, s56, 3
    s_lshl_b32 s3, s3, 15
    s_add_u32 s3, s3, s81
    s_add_u32 s3, s3, 128
    buffer_load_dwordx4 v36, s[28:31], s3 offen offset:0 lds
    buffer_load_dwordx4 v37, s[28:31], s3 offen offset:1024 lds
    buffer_load_dwordx4 v38, s[28:31], s3 offen offset:2048 lds
    buffer_load_dwordx4 v39, s[28:31], s3 offen offset:3072 lds
    s_waitcnt vmcnt(32)
    s_barrier
    s_cmp_lg_u32 s56, 0
    s_cbranch_scc1 .ba37
    s_mov_b64 exec, 1
    v_mov_b32 v21, 1
    s_and_b32 s3, s57, 0xe0
    buffer_atomic_add v21, off, s[48:51], s3 offset:4 sc1
    s_mov_b64 exec, -1
.ba37:
    v_mov_b32 v20, 0x4444
    v_mov_b32 v21, 0xeeee
    v_cmp_eq_u32 vcc, 0, v19
    s_nop 1
    v_cndmask_b32 v1, v21, v20, vcc
    v_and_b32 v22, 0x80, v0
    v_cmp_eq_u32 vcc, 0, v22
    s_nop 1
    v_cndmask_b32 v20, v21, v20, vcc
    v_lshl_or_b32 v1, v20, 16, v1
    s_not_b64 s[76:77], vcc
    v_lshlrev_b32 v20, 4, v16
    v_mov_b32 v21, 0x3f80
    v_lshlrev_b32 v21, v20, v21
    v_bfe_u32 v20, v0, 5, 2
    v_cmp_eq_u32 vcc, v20, v18
    s_nop 1
    v_cndmask_b32 v20, 0, v21, vcc
    v_cndmask_b32 v25, 0, v20, s[76:77]
    v_sub_u32 v24, v20, v25
    v_cmp_eq_u32 vcc, v17, v18
    s_nop 1
    v_cndmask_b32 v20, 0, v21, vcc
    v_cmp_eq_u32 vcc, 1, v19
    s_nop 1
    v_cndmask_b32 v27, 0, v20, vcc
    v_sub_u32 v26, v20, v27
    ds_write_b128 v0, v[24:27] offset:13312
    v_lshlrev_b32 v3, 2, v0
    v_lshlrev_b32 v3, 3, v0
    v_mov_b32 v21, 1072693248
    v_cmp_gt_u32 vcc, 2, v18
    s_nop 1
    v_cndmask_b32 v3, v21, v3, vcc
    v_mov_b32 v12, 0
    v_mov_b32 v13, 0
    v_mov_b32 v14, 0
    v_mov_b32 v15, 0
    ds_write_b128 v0, v[12:15] offset:15360
    v_bfe_u32 v20, v0, 9, 1
    v_lshlrev_b32 v4, 15, v20
    v_lshl_or_b32 v4, v17, 13, v4
    v_bfe_u32 v20, v0, 8, 1
    v_lshl_or_b32 v4, v20, 12, v4
    v_and_b32 v20, 0x30, v0
    v_or_b32 v4, v4, v20
    v_lshrrev_b32 v9, 4, v22
    v_and_b32 v20, 0x70, v0
    v_or_b32 v9, v9, v20
    v_lshl_or_b32 v9, v18, 7, v9
    s_lshl_b32 s3, s56, 9
    s_add_u32 s3, s3, 8192
    v_add_u32 v9, s3, v9
    s_lshl_b32 s3, s56, 11
    v_add_u32 v8, s3, v0
    v_mov_b32 v2, -1
    s_add_u32 s64, s3, 168820736
    v_lshlrev_b32 v20, 4, v16
    v_mov_b32 v21, 0x3f80
    v_lshlrev_b32 v24, v20, v21
    v_lshlrev_b32 v25, v20, v21
    v_lshlrev_b32 v26, v20, v21
    v_lshlrev_b32 v27, v20, v21
    ds_write_b128 v0, v[24:27] offset:14336
    s_mov_b32 s78, 0x3e0293ee
    v_mov_b32 v12, 0x3f003f00
    v_mov_b32 v13, 0x3f003f00
    v_mov_b32 v14, 0x3f803f80
    v_mov_b32 v15, 0x3f803f80
    s_mov_b32 s74, 512
    s_mov_b32 s75, 1024
    s_mov_b32 s79, 1536
    s_lshl_b32 s3, s56, 16
    s_lshl_b32 s4, s62, 6
    s_add_u32 s3, s3, s4
    s_add_u32 s67, s3, 169869312
    s_mul_i32 s3, s62, 24576
    s_lshl_b32 s4, s56, 10
    s_add_u32 s3, s3, s4
    s_add_u32 s69, s3, 2097152
    s_lshl_b32 s3, s62, 8
    s_add_u32 s83, s3, 167772160
    s_mov_b32 s71, 0
    s_mov_b64 s[72:73], 0
    s_lshl_b32 s3, s62, 2
    s_add_u32 s3, s3, s56
    s_lshl_b32 s3, s3, 12
    s_add_u32 s82, s3, 171966464
    v_lshl_or_b32 v44, v17, 1, v16
    v_lshlrev_b32 v44, 10, v44
    v_lshl_or_b32 v44, v18, 8, v44
    v_lshl_or_b32 v44, v19, 4, v44
    v_lshrrev_b32 v46, 2, v0
    s_lshl_b32 s3, s56, 5
    buffer_load_dwordx4 v[16:19], v44, s[12:15], s3 offen offset:0
    buffer_load_dwordx4 v[20:23], v44, s[12:15], s3 offen offset:128
    s_waitcnt lgkmcnt(0)
    s_waitcnt vmcnt(30)
    ds_read_b64_tr_b16 a[240:241], v28 offset:12288
    ds_read_b64_tr_b16 a[242:243], v28 offset:12544
    ds_read_b64_tr_b16 a[244:245], v28 offset:14336
    ds_read_b64_tr_b16 a[246:247], v28 offset:14592
    ds_read_b64_tr_b16 a[248:249], v28 offset:12296
    ds_read_b64_tr_b16 a[250:251], v28 offset:12552
    ds_read_b64_tr_b16 a[252:253], v28 offset:14344
    ds_read_b64_tr_b16 a[254:255], v28 offset:14600
    s_waitcnt lgkmcnt(0)
    s_xor_b32 s3, s80, 0
    s_add_u32 m0, s61, 12288
    s_nop 0
    buffer_load_dwordx4 v32, s[20:23], s3 offen offset:0 lds
    buffer_load_dwordx4 v33, s[20:23], s3 offen offset:1024 lds
    buffer_load_dwordx4 v34, s[20:23], s3 offen offset:2048 lds
    buffer_load_dwordx4 v35, s[20:23], s3 offen offset:3072 lds
    s_add_u32 m0, s61, 16384
    s_add_u32 s3, s3, 2097152
    buffer_load_dwordx4 v32, s[20:23], s3 offen offset:0 lds
    buffer_load_dwordx4 v33, s[20:23], s3 offen offset:1024 lds
    buffer_load_dwordx4 v34, s[20:23], s3 offen offset:2048 lds
    buffer_load_dwordx4 v35, s[20:23], s3 offen offset:3072 lds
    s_waitcnt vmcnt(30)
    ds_read_b64_tr_b16 a[176:177], v29 offset:20480
    ds_read_b64_tr_b16 a[178:179], v29 offset:20736
    ds_read_b64_tr_b16 a[180:181], v29 offset:22528
    ds_read_b64_tr_b16 a[182:183], v29 offset:22784
    ds_read_b64_tr_b16 a[184:185], v29 offset:20488
    ds_read_b64_tr_b16 a[186:187], v29 offset:20744
    ds_read_b64_tr_b16 a[188:189], v29 offset:22536
    ds_read_b64_tr_b16 a[190:191], v29 offset:22792
    ds_read_b64_tr_b16 a[192:193], v29 offset:24576
    ds_read_b64_tr_b16 a[194:195], v29 offset:24832
    ds_read_b64_tr_b16 a[196:197], v29 offset:26624
    ds_read_b64_tr_b16 a[198:199], v29 offset:26880
    ds_read_b64_tr_b16 a[200:201], v29 offset:24584
    ds_read_b64_tr_b16 a[202:203], v29 offset:24840
    ds_read_b64_tr_b16 a[204:205], v29 offset:26632
    ds_read_b64_tr_b16 a[206:207], v29 offset:26888
    s_waitcnt lgkmcnt(0)
    s_xor_b32 s3, s80, 524288
    s_add_u32 m0, s61, 20480
    s_nop 0
    buffer_load_dwordx4 v32, s[20:23], s3 offen offset:0 lds
    buffer_load_dwordx4 v33, s[20:23], s3 offen offset:1024 lds
    buffer_load_dwordx4 v34, s[20:23], s3 offen offset:2048 lds
    buffer_load_dwordx4 v35, s[20:23], s3 offen offset:3072 lds
    s_add_u32 m0, s61, 24576
    s_add_u32 s3, s3, 2097152
    buffer_load_dwordx4 v32, s[20:23], s3 offen offset:0 lds
    buffer_load_dwordx4 v33, s[20:23], s3 offen offset:1024 lds
    buffer_load_dwordx4 v34, s[20:23], s3 offen offset:2048 lds
    buffer_load_dwordx4 v35, s[20:23], s3 offen offset:3072 lds
    s_waitcnt vmcnt(30)
    ds_read_b64_tr_b16 a[208:209], v31 offset:0
    ds_read_b64_tr_b16 a[210:211], v31 offset:256
    ds_read_b64_tr_b16 a[212:213], v31 offset:2048
    ds_read_b64_tr_b16 a[214:215], v31 offset:2304
    ds_read_b64_tr_b16 a[216:217], v31 offset:8
    ds_read_b64_tr_b16 a[218:219], v31 offset:264
    ds_read_b64_tr_b16 a[220:221], v31 offset:2056
    ds_read_b64_tr_b16 a[222:223], v31 offset:2312
    ds_read_b64_tr_b16 a[224:225], v31 offset:4096
    ds_read_b64_tr_b16 a[226:227], v31 offset:4352
    ds_read_b64_tr_b16 a[228:229], v31 offset:6144
    ds_read_b64_tr_b16 a[230:231], v31 offset:6400
    ds_read_b64_tr_b16 a[232:233], v31 offset:4104
    ds_read_b64_tr_b16 a[234:235], v31 offset:4360
    ds_read_b64_tr_b16 a[236:237], v31 offset:6152
    ds_read_b64_tr_b16 a[238:239], v31 offset:6408
    s_waitcnt lgkmcnt(0)
    s_xor_b32 s3, s80, 262144
    s_add_u32 m0, s88, 0
    s_nop 0
    buffer_load_dwordx4 v32, s[20:23], s3 offen offset:0 lds
    buffer_load_dwordx4 v33, s[20:23], s3 offen offset:1024 lds
    buffer_load_dwordx4 v34, s[20:23], s3 offen offset:2048 lds
    buffer_load_dwordx4 v35, s[20:23], s3 offen offset:3072 lds
    s_add_u32 m0, s88, 4096
    s_add_u32 s3, s3, 2097152
    buffer_load_dwordx4 v32, s[20:23], s3 offen offset:0 lds
    buffer_load_dwordx4 v33, s[20:23], s3 offen offset:1024 lds
    buffer_load_dwordx4 v34, s[20:23], s3 offen offset:2048 lds
    buffer_load_dwordx4 v35, s[20:23], s3 offen offset:3072 lds
    s_waitcnt vmcnt(34)
    ds_read_b64_tr_b16 v[48:49], v28 offset:0
    ds_read_b64_tr_b16 v[50:51], v28 offset:256
    ds_read_b64_tr_b16 v[52:53], v28 offset:2048
    ds_read_b64_tr_b16 v[54:55], v28 offset:2304
    ds_read_b64_tr_b16 v[56:57], v28 offset:8
    ds_read_b64_tr_b16 v[58:59], v28 offset:264
    ds_read_b64_tr_b16 v[60:61], v28 offset:2056
    ds_read_b64_tr_b16 v[62:63], v28 offset:2312
    s_waitcnt lgkmcnt(0)
    ds_write_b128 v7, v[48:51] offset:0
    ds_write_b128 v7, v[52:55] offset:1024
    ds_write_b128 v7, v[56:59] offset:2048
    ds_write_b128 v7, v[60:63] offset:3072
    s_waitcnt vmcnt(30)
    ds_read_b64_tr_b16 v[64:65], v28 offset:4096
    ds_read_b64_tr_b16 v[66:67], v28 offset:4352
    ds_read_b64_tr_b16 v[68:69], v28 offset:6144
    ds_read_b64_tr_b16 v[70:71], v28 offset:6400
    ds_read_b64_tr_b16 v[72:73], v28 offset:4104
    ds_read_b64_tr_b16 v[74:75], v28 offset:4360
    ds_read_b64_tr_b16 v[76:77], v28 offset:6152
    ds_read_b64_tr_b16 v[78:79], v28 offset:6408
    s_waitcnt lgkmcnt(0)
    ds_write_b128 v7, v[64:67] offset:4096
    ds_write_b128 v7, v[68:71] offset:5120
    ds_write_b128 v7, v[72:75] offset:6144
    ds_write_b128 v7, v[76:79] offset:7168
    s_waitcnt vmcnt(26)
    ds_read_b64_tr_b16 v[80:81], v28 offset:8192
    ds_read_b64_tr_b16 v[82:83], v28 offset:8448
    ds_read_b64_tr_b16 v[84:85], v28 offset:10240
    ds_read_b64_tr_b16 v[86:87], v28 offset:10496
    ds_read_b64_tr_b16 v[88:89], v28 offset:8200
    ds_read_b64_tr_b16 v[90:91], v28 offset:8456
    ds_read_b64_tr_b16 v[92:93], v28 offset:10248
    ds_read_b64_tr_b16 v[94:95], v28 offset:10504
    s_waitcnt lgkmcnt(0)
    ds_write_b128 v7, v[80:83] offset:8192
    ds_write_b128 v7, v[84:87] offset:9216
    ds_write_b128 v7, v[88:91] offset:10240
    ds_write_b128 v7, v[92:95] offset:11264
    s_waitcnt vmcnt(16)
    s_barrier
    ds_read_b64_tr_b16 v[48:49], v40 offset:12288
    ds_read_b64_tr_b16 v[50:51], v40 offset:12544
    ds_read_b64_tr_b16 v[52:53], v40 offset:16384
    ds_read_b64_tr_b16 v[54:55], v40 offset:16640
    ds_read_b64_tr_b16 v[56:57], v40 offset:12296
    ds_read_b64_tr_b16 v[58:59], v40 offset:12552
    ds_read_b64_tr_b16 v[60:61], v40 offset:16392
    ds_read_b64_tr_b16 v[62:63], v40 offset:16648
    ds_read_b64_tr_b16 v[224:225], v41 offset:12288
    ds_read_b64_tr_b16 v[226:227], v41 offset:12544
    ds_read_b64_tr_b16 v[228:229], v41 offset:16384
    ds_read_b64_tr_b16 v[230:231], v41 offset:16640
    ds_read_b64_tr_b16 v[232:233], v41 offset:12296
    ds_read_b64_tr_b16 v[234:235], v41 offset:12552
    ds_read_b64_tr_b16 v[236:237], v41 offset:16392
    ds_read_b64_tr_b16 v[238:239], v41 offset:16648
    s_waitcnt lgkmcnt(0)
    s_barrier
    s_xor_b32 s3, s80, 786432
    s_add_u32 m0, s61, 12288
    s_nop 0
    buffer_load_dwordx4 v32, s[20:23], s3 offen offset:0 lds
    buffer_load_dwordx4 v33, s[20:23], s3 offen offset:1024 lds
    buffer_load_dwordx4 v34, s[20:23], s3 offen offset:2048 lds
    buffer_load_dwordx4 v35, s[20:23], s3 offen offset:3072 lds
    s_add_u32 m0, s61, 16384
    s_add_u32 s3, s3, 2097152
    buffer_load_dwordx4 v32, s[20:23], s3 offen offset:0 lds
    buffer_load_dwordx4 v33, s[20:23], s3 offen offset:1024 lds
    buffer_load_dwordx4 v34, s[20:23], s3 offen offset:2048 lds
    buffer_load_dwordx4 v35, s[20:23], s3 offen offset:3072 lds
    s_waitcnt vmcnt(16)
    s_barrier
    ds_read_b64_tr_b16 v[208:209], v40 offset:20480
    ds_read_b64_tr_b16 v[210:211], v40 offset:20736
    ds_read_b64_tr_b16 v[212:213], v40 offset:24576
    ds_read_b64_tr_b16 v[214:215], v40 offset:24832
    ds_read_b64_tr_b16 v[216:217], v40 offset:20488
    ds_read_b64_tr_b16 v[218:219], v40 offset:20744
    ds_read_b64_tr_b16 v[220:221], v40 offset:24584
    ds_read_b64_tr_b16 v[222:223], v40 offset:24840
    ds_read_b64_tr_b16 v[240:241], v41 offset:20480
    ds_read_b64_tr_b16 v[242:243], v41 offset:20736
    ds_read_b64_tr_b16 v[244:245], v41 offset:24576
    ds_read_b64_tr_b16 v[246:247], v41 offset:24832
    ds_read_b64_tr_b16 v[248:249], v41 offset:20488
    ds_read_b64_tr_b16 v[250:251], v41 offset:20744
    ds_read_b64_tr_b16 v[252:253], v41 offset:24584
    ds_read_b64_tr_b16 v[254:255], v41 offset:24840
    s_waitcnt lgkmcnt(0)
    s_barrier
    s_xor_b32 s3, s80, 0
    s_add_u32 m0, s61, 20480
    s_nop 0
    buffer_load_dwordx4 v32, s[24:27], s3 offen offset:0 lds
    buffer_load_dwordx4 v33, s[24:27], s3 offen offset:1024 lds
    buffer_load_dwordx4 v34, s[24:27], s3 offen offset:2048 lds
    buffer_load_dwordx4 v35, s[24:27], s3 offen offset:3072 lds
    s_add_u32 m0, s61, 24576
    s_add_u32 s3, s3, 2097152
    buffer_load_dwordx4 v32, s[24:27], s3 offen offset:0 lds
    buffer_load_dwordx4 v33, s[24:27], s3 offen offset:1024 lds
    buffer_load_dwordx4 v34, s[24:27], s3 offen offset:2048 lds
    buffer_load_dwordx4 v35, s[24:27], s3 offen offset:3072 lds
    s_waitcnt vmcnt(16)
    s_barrier
    ds_read_b64_tr_b16 a[0:1], v42 offset:0
    ds_read_b64_tr_b16 a[2:3], v42 offset:256
    ds_read_b64_tr_b16 a[4:5], v42 offset:4096
    ds_read_b64_tr_b16 a[6:7], v42 offset:4352
    ds_read_b64_tr_b16 a[8:9], v42 offset:8
    ds_read_b64_tr_b16 a[10:11], v42 offset:264
    ds_read_b64_tr_b16 a[12:13], v42 offset:4104
    ds_read_b64_tr_b16 a[14:15], v42 offset:4360
    ds_read_b64_tr_b16 a[32:33], v43 offset:0
    ds_read_b64_tr_b16 a[34:35], v43 offset:256
    ds_read_b64_tr_b16 a[36:37], v43 offset:4096
    ds_read_b64_tr_b16 a[38:39], v43 offset:4352
    ds_read_b64_tr_b16 a[40:41], v43 offset:8
    ds_read_b64_tr_b16 a[42:43], v43 offset:264
    ds_read_b64_tr_b16 a[44:45], v43 offset:4104
    ds_read_b64_tr_b16 a[46:47], v43 offset:4360
    s_waitcnt lgkmcnt(0)
    s_barrier
    s_xor_b32 s3, s80, 524288
    s_add_u32 m0, s88, 0
    s_nop 0
    buffer_load_dwordx4 v32, s[24:27], s3 offen offset:0 lds
    buffer_load_dwordx4 v33, s[24:27], s3 offen offset:1024 lds
    buffer_load_dwordx4 v34, s[24:27], s3 offen offset:2048 lds
    buffer_load_dwordx4 v35, s[24:27], s3 offen offset:3072 lds
    s_add_u32 m0, s88, 4096
    s_add_u32 s3, s3, 2097152
    buffer_load_dwordx4 v32, s[24:27], s3 offen offset:0 lds
    buffer_load_dwordx4 v33, s[24:27], s3 offen offset:1024 lds
    buffer_load_dwordx4 v34, s[24:27], s3 offen offset:2048 lds
    buffer_load_dwordx4 v35, s[24:27], s3 offen offset:3072 lds
    buffer_load_dword v45, v46, s[48:51], 0 offen sc1
    s_waitcnt vmcnt(17)
    s_barrier
    ds_read_b64_tr_b16 a[16:17], v40 offset:12288
    ds_read_b64_tr_b16 a[18:19], v40 offset:12544
    ds_read_b64_tr_b16 a[20:21], v40 offset:16384
    ds_read_b64_tr_b16 a[22:23], v40 offset:16640
    ds_read_b64_tr_b16 a[24:25], v40 offset:12296
    ds_read_b64_tr_b16 a[26:27], v40 offset:12552
    ds_read_b64_tr_b16 a[28:29], v40 offset:16392
    ds_read_b64_tr_b16 a[30:31], v40 offset:16648
    ds_read_b64_tr_b16 a[48:49], v41 offset:12288
    ds_read_b64_tr_b16 a[50:51], v41 offset:12544
    ds_read_b64_tr_b16 a[52:53], v41 offset:16384
    ds_read_b64_tr_b16 a[54:55], v41 offset:16640
    ds_read_b64_tr_b16 a[56:57], v41 offset:12296
    ds_read_b64_tr_b16 a[58:59], v41 offset:12552
    ds_read_b64_tr_b16 a[60:61], v41 offset:16392
    ds_read_b64_tr_b16 a[62:63], v41 offset:16648
    s_waitcnt lgkmcnt(0)
    s_barrier
    s_xor_b32 s3, s80, 262144
    s_add_u32 m0, s61, 12288
    s_nop 0
    buffer_load_dwordx4 v32, s[24:27], s3 offen offset:0 lds
    buffer_load_dwordx4 v33, s[24:27], s3 offen offset:1024 lds
    buffer_load_dwordx4 v34, s[24:27], s3 offen offset:2048 lds
    buffer_load_dwordx4 v35, s[24:27], s3 offen offset:3072 lds
    s_add_u32 m0, s61, 16384
    s_add_u32 s3, s3, 2097152
    buffer_load_dwordx4 v32, s[24:27], s3 offen offset:0 lds
    buffer_load_dwordx4 v33, s[24:27], s3 offen offset:1024 lds
    buffer_load_dwordx4 v34, s[24:27], s3 offen offset:2048 lds
    buffer_load_dwordx4 v35, s[24:27], s3 offen offset:3072 lds
    s_waitcnt vmcnt(17)
    s_barrier
    ds_read_b64_tr_b16 v[80:81], v40 offset:20480
    ds_read_b64_tr_b16 v[82:83], v40 offset:20736
    ds_read_b64_tr_b16 v[84:85], v40 offset:24576
    ds_read_b64_tr_b16 v[86:87], v40 offset:24832
    ds_read_b64_tr_b16 v[88:89], v40 offset:20488
    ds_read_b64_tr_b16 v[90:91], v40 offset:20744
    ds_read_b64_tr_b16 v[92:93], v40 offset:24584
    ds_read_b64_tr_b16 v[94:95], v40 offset:24840
    ds_read_b64_tr_b16 a[80:81], v41 offset:20480
    ds_read_b64_tr_b16 a[82:83], v41 offset:20736
    ds_read_b64_tr_b16 a[84:85], v41 offset:24576
    ds_read_b64_tr_b16 a[86:87], v41 offset:24832
    ds_read_b64_tr_b16 a[88:89], v41 offset:20488
    ds_read_b64_tr_b16 a[90:91], v41 offset:20744
    ds_read_b64_tr_b16 a[92:93], v41 offset:24584
    ds_read_b64_tr_b16 a[94:95], v41 offset:24840
    s_waitcnt lgkmcnt(0)
    s_barrier
    s_xor_b32 s3, s80, 786432
    s_add_u32 m0, s61, 20480
    s_nop 0
    buffer_load_dwordx4 v32, s[24:27], s3 offen offset:0 lds
    buffer_load_dwordx4 v33, s[24:27], s3 offen offset:1024 lds
    buffer_load_dwordx4 v34, s[24:27], s3 offen offset:2048 lds
    buffer_load_dwordx4 v35, s[24:27], s3 offen offset:3072 lds
    s_add_u32 m0, s61, 24576
    s_add_u32 s3, s3, 2097152
    buffer_load_dwordx4 v32, s[24:27], s3 offen offset:0 lds
    buffer_load_dwordx4 v33, s[24:27], s3 offen offset:1024 lds
    buffer_load_dwordx4 v34, s[24:27], s3 offen offset:2048 lds
    buffer_load_dwordx4 v35, s[24:27], s3 offen offset:3072 lds
    s_waitcnt vmcnt(16)
    s_barrier
    ds_read_b64_tr_b16 a[64:65], v42 offset:0
    ds_read_b64_tr_b16 a[66:67], v42 offset:256
    ds_read_b64_tr_b16 a[68:69], v42 offset:4096
    ds_read_b64_tr_b16 a[70:71], v42 offset:4352
    ds_read_b64_tr_b16 a[72:73], v42 offset:8
    ds_read_b64_tr_b16 a[74:75], v42 offset:264
    ds_read_b64_tr_b16 a[76:77], v42 offset:4104
    ds_read_b64_tr_b16 a[78:79], v42 offset:4360
    ds_read_b64_tr_b16 a[96:97], v43 offset:0
    ds_read_b64_tr_b16 a[98:99], v43 offset:256
    ds_read_b64_tr_b16 a[100:101], v43 offset:4096
    ds_read_b64_tr_b16 a[102:103], v43 offset:4352
    ds_read_b64_tr_b16 a[104:105], v43 offset:8
    ds_read_b64_tr_b16 a[106:107], v43 offset:264
    ds_read_b64_tr_b16 a[108:109], v43 offset:4104
    ds_read_b64_tr_b16 a[110:111], v43 offset:4360
    s_waitcnt lgkmcnt(0)
    s_barrier
    s_xor_b32 s3, s80, 0
    s_add_u32 m0, s88, 0
    s_nop 0
    buffer_load_dwordx4 v32, s[16:19], s3 offen offset:0 lds
    buffer_load_dwordx4 v33, s[16:19], s3 offen offset:1024 lds
    buffer_load_dwordx4 v34, s[16:19], s3 offen offset:2048 lds
    buffer_load_dwordx4 v35, s[16:19], s3 offen offset:3072 lds
    s_add_u32 m0, s88, 4096
    s_add_u32 s3, s3, 2097152
    buffer_load_dwordx4 v32, s[16:19], s3 offen offset:0 lds
    buffer_load_dwordx4 v33, s[16:19], s3 offen offset:1024 lds
    buffer_load_dwordx4 v34, s[16:19], s3 offen offset:2048 lds
    buffer_load_dwordx4 v35, s[16:19], s3 offen offset:3072 lds
    v_readlane_b32 s4, v45, 1
    s_nop 0
    s_cmp_eq_u32 s4, 32
    s_cselect_b32 s87, 1, 0
    s_cselect_b32 s86, s83, 1072693248
    buffer_load_dword v10, v46, s[52:55], s86 offen sc1
    s_waitcnt vmcnt(17)
    s_barrier
    ds_read_b64_tr_b16 a[112:113], v40 offset:12288
    ds_read_b64_tr_b16 a[114:115], v40 offset:12544
    ds_read_b64_tr_b16 a[116:117], v40 offset:16384
    ds_read_b64_tr_b16 a[118:119], v40 offset:16640
    ds_read_b64_tr_b16 a[120:121], v40 offset:12296
    ds_read_b64_tr_b16 a[122:123], v40 offset:12552
    ds_read_b64_tr_b16 a[124:125], v40 offset:16392
    ds_read_b64_tr_b16 a[126:127], v40 offset:16648
    ds_read_b64_tr_b16 a[144:145], v41 offset:12288
    ds_read_b64_tr_b16 a[146:147], v41 offset:12544
    ds_read_b64_tr_b16 a[148:149], v41 offset:16384
    ds_read_b64_tr_b16 a[150:151], v41 offset:16640
    ds_read_b64_tr_b16 a[152:153], v41 offset:12296
    ds_read_b64_tr_b16 a[154:155], v41 offset:12552
    ds_read_b64_tr_b16 a[156:157], v41 offset:16392
    ds_read_b64_tr_b16 a[158:159], v41 offset:16648
    s_waitcnt lgkmcnt(0)
    s_barrier
    s_xor_b32 s3, s80, 524288
    s_add_u32 m0, s61, 12288
    s_nop 0
    buffer_load_dwordx4 v32, s[16:19], s3 offen offset:0 lds
    buffer_load_dwordx4 v33, s[16:19], s3 offen offset:1024 lds
    buffer_load_dwordx4 v34, s[16:19], s3 offen offset:2048 lds
    buffer_load_dwordx4 v35, s[16:19], s3 offen offset:3072 lds
    s_add_u32 m0, s61, 16384
    s_add_u32 s3, s3, 2097152
    buffer_load_dwordx4 v32, s[16:19], s3 offen offset:0 lds
    buffer_load_dwordx4 v33, s[16:19], s3 offen offset:1024 lds
    buffer_load_dwordx4 v34, s[16:19], s3 offen offset:2048 lds
    buffer_load_dwordx4 v35, s[16:19], s3 offen offset:3072 lds
    s_waitcnt vmcnt(17)
    s_barrier
    ds_read_b64_tr_b16 a[128:129], v40 offset:20480
    ds_read_b64_tr_b16 a[130:131], v40 offset:20736
    ds_read_b64_tr_b16 a[132:133], v40 offset:24576
    ds_read_b64_tr_b16 a[134:135], v40 offset:24832
    ds_read_b64_tr_b16 a[136:137], v40 offset:20488
    ds_read_b64_tr_b16 a[138:139], v40 offset:20744
    ds_read_b64_tr_b16 a[140:141], v40 offset:24584
    ds_read_b64_tr_b16 a[142:143], v40 offset:24840
    ds_read_b64_tr_b16 a[160:161], v41 offset:20480
    ds_read_b64_tr_b16 a[162:163], v41 offset:20736
    ds_read_b64_tr_b16 a[164:165], v41 offset:24576
    ds_read_b64_tr_b16 a[166:167], v41 offset:24832
    ds_read_b64_tr_b16 a[168:169], v41 offset:20488
    ds_read_b64_tr_b16 a[170:171], v41 offset:20744
    ds_read_b64_tr_b16 a[172:173], v41 offset:24584
    ds_read_b64_tr_b16 a[174:175], v41 offset:24840
    s_waitcnt lgkmcnt(0)
    s_barrier
    s_xor_b32 s3, s80, 262144
    s_add_u32 m0, s61, 20480
    s_nop 0
    buffer_load_dwordx4 v32, s[16:19], s3 offen offset:0 lds
    buffer_load_dwordx4 v33, s[16:19], s3 offen offset:1024 lds
    buffer_load_dwordx4 v34, s[16:19], s3 offen offset:2048 lds
    buffer_load_dwordx4 v35, s[16:19], s3 offen offset:3072 lds
    s_add_u32 m0, s61, 24576
    s_add_u32 s3, s3, 2097152
    buffer_load_dwordx4 v32, s[16:19], s3 offen offset:0 lds
    buffer_load_dwordx4 v33, s[16:19], s3 offen offset:1024 lds
    buffer_load_dwordx4 v34, s[16:19], s3 offen offset:2048 lds
    buffer_load_dwordx4 v35, s[16:19], s3 offen offset:3072 lds
    s_waitcnt vmcnt(16)
    s_barrier
    ds_read_b64_tr_b16 v[96:97], v42 offset:0
    ds_read_b64_tr_b16 v[98:99], v42 offset:256
    ds_read_b64_tr_b16 v[100:101], v42 offset:4096
    ds_read_b64_tr_b16 v[102:103], v42 offset:4352
    ds_read_b64_tr_b16 v[104:105], v42 offset:8
    ds_read_b64_tr_b16 v[106:107], v42 offset:264
    ds_read_b64_tr_b16 v[108:109], v42 offset:4104
    ds_read_b64_tr_b16 v[110:111], v42 offset:4360
    ds_read_b64_tr_b16 v[64:65], v43 offset:0
    ds_read_b64_tr_b16 v[66:67], v43 offset:256
    ds_read_b64_tr_b16 v[68:69], v43 offset:4096
    ds_read_b64_tr_b16 v[70:71], v43 offset:4352
    ds_read_b64_tr_b16 v[72:73], v43 offset:8
    ds_read_b64_tr_b16 v[74:75], v43 offset:264
    ds_read_b64_tr_b16 v[76:77], v43 offset:4104
    ds_read_b64_tr_b16 v[78:79], v43 offset:4360
    s_waitcnt lgkmcnt(0)
    s_barrier
    s_mov_b32 s5, 0x01010101
    v_cmp_eq_u32 s[72:73], s5, v10
    buffer_load_dword v10, v46, s[52:55], s86 offen sc1
    buffer_load_dwordx4 v[24:27], v0, s[52:55], s68 offen offset:0 sc1
    buffer_load_dwordx4 v[24:27], v0, s[52:55], s68 offen offset:1024 sc1
    s_and_b32 s3, s62, 3
    s_lshl_b32 s3, s3, 13
    s_add_u32 s3, s3, s64
    buffer_load_dwordx4 v[24:27], v0, s[52:55], s3 offen offset:0 sc1
    buffer_load_dwordx4 v[24:27], v0, s[52:55], s3 offen offset:1024 sc1
    s_mul_i32 s3, s56, 3072
    s_add_u32 s3, s3, s69
    s_bitcmp1_b32 s72, 0
    s_cselect_b32 s4, s3, 1072693248
    buffer_load_dword v11, v3, s[52:55], s4 offen sc1
    s_xor_b32 s3, s80, 786432
    s_add_u32 m0, s88, 0
    s_nop 0
    buffer_load_dwordx4 v32, s[16:19], s3 offen offset:0 lds
    buffer_load_dwordx4 v33, s[16:19], s3 offen offset:1024 lds
    buffer_load_dwordx4 v34, s[16:19], s3 offen offset:2048 lds
    buffer_load_dwordx4 v35, s[16:19], s3 offen offset:3072 lds
    s_add_u32 m0, s88, 4096
    s_add_u32 s3, s3, 2097152
    buffer_load_dwordx4 v32, s[16:19], s3 offen offset:0 lds
    buffer_load_dwordx4 v33, s[16:19], s3 offen offset:1024 lds
    buffer_load_dwordx4 v34, s[16:19], s3 offen offset:2048 lds
    buffer_load_dwordx4 v35, s[16:19], s3 offen offset:3072 lds
    s_waitcnt vmcnt(22)
    s_barrier
    ds_read_b64_tr_b16 v[112:113], v40 offset:12288
    ds_read_b64_tr_b16 v[114:115], v40 offset:12544
    ds_read_b64_tr_b16 v[116:117], v40 offset:16384
    ds_read_b64_tr_b16 v[118:119], v40 offset:16640
    ds_read_b64_tr_b16 v[120:121], v40 offset:12296
    ds_read_b64_tr_b16 v[122:123], v40 offset:12552
    ds_read_b64_tr_b16 v[124:125], v40 offset:16392
    ds_read_b64_tr_b16 v[126:127], v40 offset:16648
    ds_read_b64_tr_b16 v[128:129], v41 offset:12288
    ds_read_b64_tr_b16 v[130:131], v41 offset:12544
    ds_read_b64_tr_b16 v[132:133], v41 offset:16384
    ds_read_b64_tr_b16 v[134:135], v41 offset:16640
    ds_read_b64_tr_b16 v[136:137], v41 offset:12296
    ds_read_b64_tr_b16 v[138:139], v41 offset:12552
    ds_read_b64_tr_b16 v[140:141], v41 offset:16392
    ds_read_b64_tr_b16 v[142:143], v41 offset:16648
    s_waitcnt lgkmcnt(0)
    s_barrier
    s_waitcnt vmcnt(9)
    s_barrier
    ds_read_b64_tr_b16 v[144:145], v40 offset:20480
    ds_read_b64_tr_b16 v[146:147], v40 offset:20736
    ds_read_b64_tr_b16 v[148:149], v40 offset:24576
    ds_read_b64_tr_b16 v[150:151], v40 offset:24832
    ds_read_b64_tr_b16 v[152:153], v40 offset:20488
    ds_read_b64_tr_b16 v[154:155], v40 offset:20744
    ds_read_b64_tr_b16 v[156:157], v40 offset:24584
    ds_read_b64_tr_b16 v[158:159], v40 offset:24840
    ds_read_b64_tr_b16 v[176:177], v41 offset:20480
    ds_read_b64_tr_b16 v[178:179], v41 offset:20736
    ds_read_b64_tr_b16 v[180:181], v41 offset:24576
    ds_read_b64_tr_b16 v[182:183], v41 offset:24832
    ds_read_b64_tr_b16 v[184:185], v41 offset:20488
    ds_read_b64_tr_b16 v[186:187], v41 offset:20744
    ds_read_b64_tr_b16 v[188:189], v41 offset:24584
    ds_read_b64_tr_b16 v[190:191], v41 offset:24840
    s_waitcnt lgkmcnt(0)
    s_barrier
    s_mov_b32 s5, 0x01010101
    v_cmp_eq_u32 s[72:73], s5, v10
    buffer_load_dword v10, v46, s[52:55], s86 offen sc1
    s_mul_i32 s3, s56, 3072
    s_add_u32 s3, s3, s69
    s_bitcmp1_b32 s72, 0
    s_cselect_b32 s4, s3, 1072693248
    buffer_load_dword v11, v3, s[52:55], s4 offen sc1
    ds_write_b128 v7, v[96:99] offset:12288
    ds_write_b128 v7, v[100:103] offset:13312
    ds_write_b128 v7, v[104:107] offset:14336
    ds_write_b128 v7, v[108:111] offset:15360
    ds_write_b128 v7, v[64:67] offset:16384
    ds_write_b128 v7, v[68:71] offset:17408
    ds_write_b128 v7, v[72:75] offset:18432
    ds_write_b128 v7, v[76:79] offset:19456
    ds_write_b128 v7, v[48:51] offset:20480
    ds_write_b128 v7, v[52:55] offset:21504
    ds_write_b128 v7, v[56:59] offset:22528
    ds_write_b128 v7, v[60:63] offset:23552
    ds_write_b128 v7, v[80:83] offset:24576
    ds_write_b128 v7, v[84:87] offset:25600
    ds_write_b128 v7, v[88:91] offset:26624
    ds_write_b128 v7, v[92:95] offset:27648
    s_waitcnt vmcnt(1)
    s_barrier
    ds_read_b64_tr_b16 v[160:161], v42 offset:0
    ds_read_b64_tr_b16 v[162:163], v42 offset:256
    ds_read_b64_tr_b16 v[164:165], v42 offset:4096
    ds_read_b64_tr_b16 v[166:167], v42 offset:4352
    ds_read_b64_tr_b16 v[168:169], v42 offset:8
    ds_read_b64_tr_b16 v[170:171], v42 offset:264
    ds_read_b64_tr_b16 v[172:173], v42 offset:4104
    ds_read_b64_tr_b16 v[174:175], v42 offset:4360
    ds_read_b64_tr_b16 v[192:193], v43 offset:0
    ds_read_b64_tr_b16 v[194:195], v43 offset:256
    ds_read_b64_tr_b16 v[196:197], v43 offset:4096
    ds_read_b64_tr_b16 v[198:199], v43 offset:4352
    ds_read_b64_tr_b16 v[200:201], v43 offset:8
    ds_read_b64_tr_b16 v[202:203], v43 offset:264
    ds_read_b64_tr_b16 v[204:205], v43 offset:4104
    ds_read_b64_tr_b16 v[206:207], v43 offset:4360
    s_waitcnt lgkmcnt(0)
    s_barrier
    s_mov_b32 s5, 0x01010101
    v_cmp_eq_u32 s[72:73], s5, v10
    s_waitcnt lgkmcnt(0)
    s_cmp_lg_u32 s87, 0
    s_cbranch_scc1 .Lb1ok
    v_lshrrev_b32 v46, 2, v0
    s_mov_b32 s6, 0x02020202
    s_mov_b32 s7, 0x02020202
    s_mov_b32 s59, 40000
    s_cmp_lg_u32 s58, 0
    s_cselect_b32 s59, 1, s59
.spin38:
    buffer_load_dword v45, v46, s[48:51], 0 offen sc1
    s_waitcnt vmcnt(0)
    v_cmp_eq_u32 vcc, 32, v45
    s_and_b64 s[4:5], vcc, s[6:7]
    s_cmp_eq_u64 s[4:5], s[6:7]
    s_cbranch_scc1 .spinx39
    s_sub_u32 s59, s59, 1
    s_cmp_lg_u32 s59, 0
    s_cbranch_scc1 .spin38
    s_mov_b32 s58, 1
.spinx39:
    buffer_load_dwordx4 v[24:27], v0, s[52:55], s68 offen offset:0 sc1
    buffer_load_dwordx4 v[24:27], v0, s[52:55], s68 offen offset:1024 sc1
    s_and_b32 s3, s62, 3
    s_lshl_b32 s3, s3, 13
    s_add_u32 s3, s3, s64
    buffer_load_dwordx4 v[24:27], v0, s[52:55], s3 offen offset:0 sc1
    buffer_load_dwordx4 v[24:27], v0, s[52:55], s3 offen offset:1024 sc1
    s_waitcnt vmcnt(0)
.Lb1ok:
    v_readlane_b32 s3, v45, 2
    s_nop 0
    s_bcnt1_i32_b32 s80, s3
    s_mov_b32 s4, 0x05040100
    s_mov_b32 s5, 0x07060302
    v_perm_b32 v24, v18, v16, s4
    v_perm_b32 v25, v18, v16, s5
    v_perm_b32 v26, v19, v17, s4
    v_perm_b32 v27, v19, v17, s5
    v_perm_b32 v28, v22, v20, s4
    v_perm_b32 v29, v22, v20, s5
    v_perm_b32 v30, v23, v21, s4
    v_perm_b32 v31, v23, v21, s5
    s_lshl_b32 s3, s56, 11
    s_add_u32 s85, s3, 168820736
    s_lshl_b32 s3, s62, 2
    s_add_u32 s3, s3, s56
    s_lshl_b32 s3, s3, 10
    s_cmp_eq_u32 s80, 1
    s_cselect_b32 s3, s64, 1072693248
    s_cselect_b32 s4, 1072693248, s64
    buffer_store_dwordx4 v[28:31], v0, s[52:55], s3 offen offset:1024
    buffer_store_dwordx4 v[28:31], v0, s[52:55], s4 offen offset:1024 sc1
    s_lshl_b32 s3, s56, 11
    s_add_u32 s4, s3, 69206016
    s_cmp_eq_u32 s62, 0
    s_cselect_b32 s4, s4, 1072693248
    buffer_store_dwordx4 v[24:27], v0, s[52:55], s4 offen offset:0 sc1
    buffer_store_dwordx4 v[28:31], v0, s[52:55], s4 offen offset:1024 sc1
    s_mov_b32 s62, 0
    s_mov_b32 s65, s84
    s_mov_b32 s60, 40000
    s_mov_b32 s59, 40000
    s_add_u32 s61, s69, 4096
    s_lshl_b32 s3, s56, 10
    s_add_u32 s3, s3, s69
    s_add_u32 s63, s3, 8192
    s_lshl_b32 m0, s56, 11
    s_mov_b32 s5, 0x01010101
    s_mov_b32 s2, 8192
    s_mov_b32 s3, 786432
    s_mul_i32 s0, s56, 3072
    s_add_u32 s0, s0, 786432
    s_mov_b32 s81, 0
    s_bitcmp1_b32 s72, 0
    s_cbranch_scc1 .Lkv0
    v_lshrrev_b32 v23, 2, v0
    s_mov_b32 s4, s60
.kvw40:
    buffer_load_dword v10, v23, s[52:55], s83 offen sc1
    s_waitcnt vmcnt(0)
    v_cmp_eq_u32 s[72:73], s5, v10
    s_nop 1
    s_bitcmp1_b64 s[72:73], s81
    s_cbranch_scc1 .Lkv0
    s_sub_u32 s4, s4, 1
    s_cbranch_scc0 .kvw40
    s_mov_b32 s60, 0
    s_branch .Lkv0
.Lkv0:
    ds_read_b128 v[48:51], v7 offset:20480
    ds_read_b128 v[52:55], v7 offset:21504
    ds_read_b128 v[56:59], v7 offset:22528
    ds_read_b128 v[60:63], v7 offset:23552
    ds_read_b128 v[88:91], v7 offset:26624
    ds_read_b128 v[92:95], v7 offset:27648
    ds_read_b128 v[96:99], v7 offset:12288
    ds_read_b128 v[100:103], v7 offset:13312
    ds_read_b128 v[104:107], v7 offset:14336
    ds_read_b128 v[108:111], v7 offset:15360
    ds_read_b128 v[80:83], v7 offset:24576
    ds_read_b128 v[84:87], v7 offset:25600
    ds_read_b128 v[64:67], v7 offset:16384
    ds_read_b128 v[68:71], v7 offset:17408
    v_mov_b64 v[32:33], 0
    v_mov_b64 v[34:35], 0
    v_mov_b64 v[36:37], 0
    v_mov_b64 v[38:39], 0
    v_mov_b64 v[40:41], 0
    v_mov_b64 v[42:43], 0
    v_mov_b64 v[44:45], 0
    v_mov_b64 v[46:47], 0
    v_mov_b64 v[72:73], 0
    v_mov_b64 v[74:75], 0
    v_mov_b64 v[76:77], 0
    v_mov_b64 v[78:79], 0
    v_xor_b32 v20, 2048, v8
    v_xor_b32 v21, 4096, v8
    v_xor_b32 v22, 6144, v8
    s_add_u32 s1, s81, 1
    s_bitcmp1_b64 s[72:73], s1
    s_cselect_b32 s1, s0, 1072693248
    s_add_u32 s1, s1, s69
    s_waitcnt vmcnt(2) lgkmcnt(0)
    s_mov_b32 s66, 1072693248
    s_cmp_eq_u32 s80, 1
    s_mov_b32 s80, 1072693248
    s_cbranch_scc0 .LokS
    s_branch .LokF
.LtopF:
    s_bitcmp1_b32 s56, 0
    s_cbranch_scc1 .os41
    s_waitcnt vmcnt(0)
.os41:
    buffer_load_dwordx4 v[24:27], v0, s[52:55], s64 offen offset:0 sc1
    v_cmp_eq_u32 s[72:73], s5, v10
    s_bitcmp1_b64 s[72:73], s81
    s_cbranch_scc0 .LkvwF
.LkvokF:
    v_xor_b32 v20, 2048, v8
    v_xor_b32 v21, 4096, v8
    v_xor_b32 v22, 6144, v8
    s_add_u32 s1, s81, 1
    s_bitcmp1_b64 s[72:73], s1
    s_cselect_b32 s1, s0, 1072693248
    s_add_u32 s1, s1, s69
    v_mov_b64 v[36:37], 0
    v_mov_b64 v[38:39], 0
    v_mov_b64 v[44:45], 0
    v_mov_b64 v[46:47], 0
    v_mov_b64 v[72:73], 0
    v_mov_b64 v[74:75], 0
    v_mov_b64 v[76:77], 0
    v_mov_b64 v[78:79], 0
    s_mov_b32 s59, s60
    s_xor_b32 s71, s71, 1
    s_mov_b64 vcc, -1
.Lp2F:
    s_mov_b64 exec, vcc
    buffer_load_dwordx4 v[24:27], v0, s[52:55], s64 offen offset:0 sc1
    s_mov_b64 exec, -1
    s_sub_u32 s59, s59, 1
    s_cbranch_scc1 .LgiveF
    v_mov_b64 v[40:41], 0
    v_mov_b64 v[42:43], 0
    v_mov_b64 v[32:33], 0
    v_mov_b64 v[34:35], 0
    s_waitcnt vmcnt(1) lgkmcnt(0)
.LokF:
    v_max3_u32 v16, v24, v25, v26
    v_max_u32 v16, v16, v27
    v_smfmac_f32_16x16x64_bf16 v[40:43], v[24:27], v[48:55], v1
    ds_write_b128 v8, v[24:27]
    v_cmp_eq_u32 vcc, -1, v16
    v_smfmac_f32_16x16x64_bf16 v[32:35], v[24:27], v[96:103], v1
    s_cbranch_vccnz .Lp2F
.LcontF:
    s_waitcnt lgkmcnt(0)
    s_barrier
    ds_read_b128 v[48:51], v20 offset:0
    buffer_load_dwordx4 v0, s[52:55], s64 offen offset:1024 sc1 lds
    v_smfmac_f32_16x16x64_bf16 v[44:47], v[24:27], v[56:63], v1
    ds_read_b128 v[56:59], v21 offset:0
    ds_read_b128 v[60:63], v22 offset:0
    v_smfmac_f32_16x16x64_bf16 v[72:75], v[24:27], v[80:87], v1
    v_smfmac_f32_16x16x64_bf16 v[36:39], v[24:27], v[104:111], v1
    v_smfmac_f32_16x16x64_bf16 v[76:79], v[24:27], v[88:95], v1
    ds_read_b128 v[96:99], v7 offset:18432
    ds_read_b128 v[100:103], v7 offset:19456
    s_waitcnt lgkmcnt(4)
    v_smfmac_f32_16x16x64_bf16 v[32:35], v[48:51], v[64:71], v1
    s_mov_b64 vcc, s[76:77]
    v_smfmac_f32_16x16x64_bf16 v[40:43], v[48:51], v[224:231], v1
    buffer_load_dwordx4 v[108:111], v0, s[52:55], s61 offen offset:0 sc1
    v_smfmac_f32_16x16x64_bf16 v[44:47], v[48:51], v[232:239], v1
    s_waitcnt lgkmcnt(3)
    v_smfmac_f32_16x16x64_bf16 v[32:35], v[56:59], v[144:151], v1
    v_mov_b64 v[88:89], 0
    v_smfmac_f32_16x16x64_bf16 v[36:39], v[56:59], v[152:159], v1
    buffer_load_dwordx4 v[104:107], v0, s[52:55], s69 offen offset:0 sc1
    s_waitcnt lgkmcnt(0)
    v_smfmac_f32_16x16x64_bf16 v[36:39], v[48:51], v[96:103], v1
    v_mov_b64 v[90:91], 0
    v_smfmac_f32_16x16x64_bf16 v[32:35], v[60:63], v[176:183], v1
    ds_read_b128 v[100:103], v0 offset:13312
    v_smfmac_f32_16x16x64_bf16 v[36:39], v[60:63], v[184:191], v1
    buffer_load_dwordx4 v[80:83], v0, s[52:55], s63 offen offset:0 sc1
    v_smfmac_f32_16x16x64_bf16 v[72:75], v[56:59], a[112:119], v1
    v_mov_b64 v[92:93], 0
    v_smfmac_f32_16x16x64_bf16 v[76:79], v[56:59], a[120:127], v1
    v_mov_b64 v[94:95], 0
    v_smfmac_f32_16x16x64_bf16 v[72:75], v[60:63], a[144:151], v1
    buffer_load_dwordx4 v[84:87], v0, s[52:55], s63 offen offset:1024 sc1
    v_smfmac_f32_16x16x64_bf16 v[76:79], v[60:63], a[152:159], v1
    v_smfmac_f32_16x16x64_bf16 v[40:43], v[56:59], a[0:7], v1
    s_waitcnt vmcnt(4)
    s_barrier
    ds_read_b128 v[28:31], v8 offset:1024
    v_smfmac_f32_16x16x64_bf16 v[44:47], v[56:59], a[8:15], v1
    ds_read_b128 v[52:55], v20 offset:1024
    ds_read_b128 v[64:67], v21 offset:1024
    v_smfmac_f32_16x16x64_bf16 v[40:43], v[60:63], a[32:39], v1
    buffer_load_dword v10, v3, s[52:55], s1 offen sc1
    ds_read_b128 v[68:71], v22 offset:1024
    v_smfmac_f32_16x16x64_bf16 v[44:47], v[60:63], a[40:47], v1
    buffer_store_dword v11, v6, s[52:55], s80 offen sc1
    v_smfmac_f32_16x16x64_bf16 v[72:75], v[48:51], a[80:87], v1
    v_smfmac_f32_16x16x64_bf16 v[76:79], v[48:51], a[88:95], v1
    s_waitcnt lgkmcnt(2)
    v_smfmac_f32_16x16x64_bf16 v[32:35], v[28:31], v[112:119], v1
    v_smfmac_f32_16x16x64_bf16 v[32:35], v[52:55], v[128:135], v1
    s_waitcnt lgkmcnt(0)
    v_smfmac_f32_16x16x64_bf16 v[32:35], v[64:67], v[160:167], v1
    s_waitcnt vmcnt(5)
    v_swap_b32 v108, v110
    v_smfmac_f32_16x16x64_bf16 v[32:35], v[68:71], v[192:199], v1
    v_swap_b32 v109, v111
    v_smfmac_f32_16x16x64_bf16 v[36:39], v[28:31], v[120:127], v1
    v_smfmac_f32_16x16x64_bf16 v[36:39], v[52:55], v[136:143], v1
    ds_read_b128 v[56:59], v7 offset:4096
    v_add_f32 v32, v32, v34
    v_smfmac_f32_16x16x64_bf16 v[36:39], v[64:67], v[168:175], v1
    ds_read_b128 v[60:63], v7 offset:5120
    v_add_f32 v33, v33, v35
    v_smfmac_f32_16x16x64_bf16 v[36:39], v[68:71], v[200:207], v1
    ds_read_b128 v[48:51], v7 offset:2048
    v_cmp_u_f32 s[6:7], v32, v33
    v_smfmac_f32_16x16x64_bf16 v[40:43], v[28:31], v[208:215], v1
    ds_read_b128 v[24:27], v7 offset:8192
    v_cvt_pk_bf16_f32 v32, v32, v33
    v_smfmac_f32_16x16x64_bf16 v[40:43], v[52:55], v[240:247], v1
    v_add_f32 v36, v36, v38
    v_smfmac_f32_16x16x64_bf16 v[40:43], v[64:67], a[16:23], v1
    v_add_f32 v37, v37, v39
    v_smfmac_f32_16x16x64_bf16 v[40:43], v[68:71], a[48:55], v1
    v_cvt_pk_bf16_f32 v33, v36, v37
    v_smfmac_f32_16x16x64_bf16 v[44:47], v[28:31], v[216:223], v1
    buffer_load_dword v10, v5, s[52:55], s83 offen sc1
    v_mfma_f32_16x16x16_bf16 v[96:99], v[32:33], v[100:101], 0
    v_add_f32 v40, v40, v42
    v_add_f32 v41, v41, v43
    v_smfmac_f32_16x16x64_bf16 v[44:47], v[52:55], v[248:255], v1
    ds_read_b128 v[32:35], v7 offset:10240
    v_cvt_pk_bf16_f32 v40, v40, v41
    v_smfmac_f32_16x16x64_bf16 v[44:47], v[64:67], a[24:31], v1
    v_cvt_pk_bf16_f32 v96, v96, v97
    v_smfmac_f32_16x16x64_bf16 v[44:47], v[68:71], a[56:63], v1
    v_cvt_pk_bf16_f32 v97, v98, v99
    v_smfmac_f32_16x16x64_bf16 v[72:75], v[28:31], a[64:71], v1
    v_mov_b32_dpp v98, v96 row_ror:8 row_mask:0xf bank_mask:0xf
    v_mov_b32_dpp v99, v97 row_ror:8 row_mask:0xf bank_mask:0xf
    v_add_f32 v44, v44, v46
    v_add_f32 v45, v45, v47
    v_cvt_pk_bf16_f32 v41, v44, v45
    s_waitcnt vmcnt(5)
    v_mfma_f32_16x16x32_bf16 v[16:19], v[104:107], v[96:99], 0
    v_mfma_f32_16x16x16_bf16 v[44:47], v[40:41], v[102:103], 0
    v_mfma_f32_16x16x32_bf16 v[36:39], v[108:111], v[96:99], 0
    v_smfmac_f32_16x16x64_bf16 v[72:75], v[52:55], a[96:103], v1
    v_cvt_pk_bf16_f32 v44, v44, v45
    v_cvt_pk_bf16_f32 v45, v46, v47
    v_cndmask_b32 v16, v16, v36, vcc
    v_cndmask_b32 v17, v17, v37, vcc
    v_mfma_f32_16x16x16_bf16 v[40:43], v[44:45], v[96:97], 0
    v_cndmask_b32 v18, v18, v38, vcc
    v_cndmask_b32 v19, v19, v39, vcc
    v_smfmac_f32_16x16x64_bf16 v[72:75], v[64:67], a[128:135], v1
    ds_write_b128 v8, v[16:19] offset:16384
    s_nop 2
    v_cndmask_b32 v40, v40, v42, vcc
    v_cndmask_b32 v41, v41, v43, vcc
    ds_write_b64 v8, v[40:41] offset:17408
    v_smfmac_f32_16x16x64_bf16 v[72:75], v[68:71], a[160:167], v1
    s_cmp_lg_u64 s[6:7], 0
    s_cbranch_scc1 .LplF
.LlokF:
    s_waitcnt lgkmcnt(1)
    s_barrier
    ds_read_b128 v[104:107], v20 offset:16384
    v_smfmac_f32_16x16x64_bf16 v[76:79], v[28:31], a[72:79], v1
    ds_read_b128 v[108:111], v21 offset:16384
    ds_read_b128 v[36:39], v22 offset:16384
    v_smfmac_f32_16x16x64_bf16 v[76:79], v[52:55], a[104:111], v1
    s_waitcnt lgkmcnt(3)
    s_barrier
    ds_read_b64 v[96:97], v20 offset:17408
    v_add_f32 v72, v72, v74
    v_smfmac_f32_16x16x64_bf16 v[76:79], v[64:67], a[136:143], v1
    ds_read_b64 v[98:99], v21 offset:17408
    v_add_f32 v73, v73, v75
    v_smfmac_f32_16x16x64_bf16 v[76:79], v[68:71], a[168:175], v1
    ds_read_b64 v[100:101], v22 offset:17408
    v_cvt_pk_bf16_f32 v72, v72, v73
    s_waitcnt lgkmcnt(5)
    v_add_f32 v16, v16, v104
    v_add_f32 v17, v17, v105
    v_add_f32 v18, v18, v106
    v_add_f32 v19, v19, v107
    s_waitcnt lgkmcnt(3)
    v_pk_add_f32 v[108:109], v[108:109], v[36:37]
    v_pk_add_f32 v[110:111], v[110:111], v[38:39]
    v_pk_add_f32 v[16:17], v[16:17], v[108:109]
    v_pk_add_f32 v[18:19], v[18:19], v[110:111]
    v_max3_f32 v23, v16, v17, v18
    v_max_f32 v23, v23, v19
    s_waitcnt lgkmcnt(0)
    v_pk_add_f32 v[40:41], v[40:41], v[96:97]
    v_pk_add_f32 v[98:99], v[98:99], v[100:101]
    v_pk_add_f32 v[40:41], v[40:41], v[98:99]
    v_max_f32_dpp v23, v23, v23 row_ror:8 row_mask:0xf bank_mask:0xf
    v_add_f32 v76, v76, v78
    v_add_f32_dpp v40, v40, v40 row_ror:8 row_mask:0xf bank_mask:0xf
    v_add_f32_dpp v41, v41, v41 row_ror:8 row_mask:0xf bank_mask:0xf
    v_max3_f32 v20, v40, v41, v23
    v_max3_f32 v21, v40, v41, v23
    v_add_f32 v77, v77, v79
    v_cvt_pk_bf16_f32 v73, v76, v77
    v_permlane16_swap_b32 v20, v21
    v_max_f32 v21, v20, v21
    v_max_f32 v20, v20, v21
    v_mov_b64 v[74:75], 0
    ds_read_b128 v[36:39], v7 offset:11264
    v_permlane32_swap_b32 v21, v20
    v_max_f32 v20, v20, v21
    v_mul_f32 v20, s78, v20
    v_pk_fma_f32 v[40:41], v[40:41], s[78:79], v[20:21] op_sel_hi:[1,0,0] neg_lo:[0,0,1] neg_hi:[0,0,1]
    v_exp_f32 v40, v40
    v_exp_f32 v41, v41
    v_pk_fma_f32 v[16:17], v[16:17], s[78:79], v[20:21] op_sel_hi:[1,0,0] neg_lo:[0,0,1] neg_hi:[0,0,1]
    v_pk_fma_f32 v[18:19], v[18:19], s[78:79], v[20:21] op_sel_hi:[1,0,0] neg_lo:[0,0,1] neg_hi:[0,0,1]
    v_cvt_pk_bf16_f32 v40, v40, v41
    v_exp_f32 v16, v16
    v_exp_f32 v17, v17
    v_mov_b32_dpp v74, v40 quad_perm:[0,1,2,3] row_mask:0xf bank_mask:0x3
    v_mov_b32_dpp v75, v40 quad_perm:[0,1,2,3] row_mask:0xf bank_mask:0xc
    v_cvt_pk_bf16_f32 v76, v16, v17
    v_exp_f32 v18, v18
    v_exp_f32 v19, v19
    v_mov_b32_dpp v78, v76 row_ror:8 row_mask:0xf bank_mask:0xf
    v_cvt_pk_bf16_f32 v77, v18, v19
    v_mfma_f32_16x16x16_bf16 v[96:99], v[72:73], v[74:75], 0
    s_nop 0
    v_mov_b32_dpp v79, v77 row_ror:8 row_mask:0xf bank_mask:0xf
    v_bitop3_b32 v21, v9, -9, s74 bitop3:0x6a
    v_mfma_f32_16x16x32_bf16 v[100:103], v[12:15], v[74:77], 0
    s_waitcnt vmcnt(3)
    v_bitop3_b32 v22, v9, -9, s75 bitop3:0x6a
    v_bitop3_b32 v23, v9, -9, s79 bitop3:0x6a
    v_mfma_f32_16x16x32_bf16 v[104:107], v[80:83], v[76:79], v[96:99]
    ds_read_b128 v[80:83], v0 offset:15360
    ds_read_b128 v[40:43], v7 offset:0
    v_mfma_f32_16x16x32_bf16 v[108:111], v[84:87], v[76:79], v[96:99]
    ds_read_b128 v[84:87], v0 offset:15360
    v_add_f32_dpp v20, v100, v100 row_ror:8 row_mask:0xf bank_mask:0xf
    v_rcp_f32 v20, v20
    s_nop 0
    v_cndmask_b32 v102, 0, v20, vcc
    v_sub_f32 v100, v20, v102
    v_pk_mul_f32 v[104:105], v[104:105], v[100:101] op_sel_hi:[1,0]
    v_pk_mul_f32 v[106:107], v[106:107], v[100:101] op_sel_hi:[1,0]
    v_pk_fma_f32 v[104:105], v[108:109], v[102:103], v[104:105] op_sel_hi:[1,0,1]
    v_pk_fma_f32 v[106:107], v[110:111], v[102:103], v[106:107] op_sel_hi:[1,0,1]
    v_cvt_pk_bf16_f32 v16, v104, v105
    v_cvt_pk_bf16_f32 v17, v106, v107
    ds_write_b64 v9, v[16:17]
    v_mov_b32_dpp v18, v16 row_ror:8 row_mask:0xf bank_mask:0xf
    v_mov_b32_dpp v19, v17 row_ror:8 row_mask:0xf bank_mask:0xf
    s_nop 1
    v_smfmac_f32_16x16x64_bf16 v[88:91], v[16:19], a[176:183], v1 abid:1
    v_smfmac_f32_16x16x64_bf16 v[92:95], v[16:19], a[184:191], v1 abid:1
    s_waitcnt lgkmcnt(0)
    s_barrier
    ds_read_b128 v[96:99], v21 offset:0
    ds_read_b128 v[104:107], v22 offset:0
    ds_read_b128 v[108:111], v23 offset:0
    v_smfmac_f32_16x16x64_bf16 v[80:83], v[16:19], a[192:199], v1 abid:1
    v_smfmac_f32_16x16x64_bf16 v[84:87], v[16:19], a[200:207], v1 abid:1
    s_waitcnt lgkmcnt(2)
    v_smfmac_f32_16x16x64_bf16 v[88:91], v[96:99], a[208:215], v1 abid:1
    ds_read_b128 v[44:47], v7 offset:1024
    v_smfmac_f32_16x16x64_bf16 v[92:95], v[96:99], a[216:223], v1 abid:1
    s_waitcnt lgkmcnt(2)
    ds_read_b128 v[28:31], v7 offset:9216
    v_smfmac_f32_16x16x64_bf16 v[88:91], v[104:107], a[224:231], v1 abid:1
    ds_read_b128 v[52:55], v7 offset:3072
    v_smfmac_f32_16x16x64_bf16 v[92:95], v[104:107], a[232:239], v1 abid:1
    s_waitcnt lgkmcnt(3)
    ds_read_b128 v[64:67], v7 offset:6144
    v_smfmac_f32_16x16x64_bf16 v[88:91], v[108:111], a[240:247], v1 abid:1
    ds_read_b128 v[68:71], v7 offset:7168
    v_smfmac_f32_16x16x64_bf16 v[92:95], v[108:111], a[248:255], v1 abid:1
    s_waitcnt lgkmcnt(4)
    v_smfmac_f32_16x16x64_bf16 v[80:83], v[96:99], v[40:47], v1 abid:1
    s_nop 3
    v_cvt_pk_bf16_f32 v88, v88, v92
    v_cvt_pk_bf16_f32 v89, v89, v93
    v_bfi_b32 v88, 1, s71, v88
    v_cvt_pk_bf16_f32 v90, v90, v94
    v_cvt_pk_bf16_f32 v91, v91, v95
    buffer_store_dwordx4 v[88:91], v4, s[52:55], s67 offen offset:0
    v_smfmac_f32_16x16x64_bf16 v[80:83], v[104:107], v[56:63], v1 abid:1
    s_waitcnt lgkmcnt(0)
    v_smfmac_f32_16x16x64_bf16 v[80:83], v[108:111], v[24:31], v1 abid:1
    ds_read_b128 v[40:43], v0 offset:14336
    v_smfmac_f32_16x16x64_bf16 v[84:87], v[96:99], v[48:55], v1 abid:1
    v_smfmac_f32_16x16x64_bf16 v[84:87], v[104:107], v[64:71], v1 abid:1
    v_smfmac_f32_16x16x64_bf16 v[84:87], v[108:111], v[32:39], v1 abid:1
    s_nop 7
    v_cvt_pk_bf16_f32 v80, v80, v84
    v_cvt_pk_bf16_f32 v81, v81, v85
    v_bfi_b32 v80, 1, s71, v80
    v_cvt_pk_bf16_f32 v82, v82, v86
    v_cvt_pk_bf16_f32 v83, v83, v87
    buffer_store_dwordx4 v[80:83], v4, s[52:55], s67 offen offset:2048
    ds_read_b128 v[48:51], v7 offset:20480
    ds_read_b128 v[52:55], v7 offset:21504
    ds_read_b128 v[56:59], v7 offset:22528
    ds_read_b128 v[60:63], v7 offset:23552
    ds_read_b128 v[88:91], v7 offset:26624
    ds_read_b128 v[92:95], v7 offset:27648
    ds_read_b128 v[96:99], v7 offset:12288
    ds_read_b128 v[100:103], v7 offset:13312
    ds_read_b128 v[104:107], v7 offset:14336
    ds_read_b128 v[108:111], v7 offset:15360
    ds_read_b128 v[80:83], v7 offset:24576
    ds_read_b128 v[84:87], v7 offset:25600
    ds_read_b128 v[64:67], v7 offset:16384
    ds_read_b128 v[68:71], v7 offset:17408
    s_mov_b32 s66, s65
    s_add_u32 s62, s62, s2
    s_and_b32 s62, s62, 0x6000
    s_add_u32 s65, s84, s62
    s_add_u32 s64, s85, s62
    s_add_u32 s70, s70, s2
    s_mov_b32 s80, s70
    s_mov_b32 s59, s60
    s_add_u32 s81, s81, 1
    s_add_u32 s69, s69, s3
    s_add_u32 s61, s61, s3
    s_add_u32 s63, s63, s3
    s_bitcmp1_b32 s56, 0
    s_cbranch_scc0 .os42
    s_waitcnt vmcnt(0)
.os42:
    s_waitcnt vmcnt(1)
    buffer_load_dword v24, v5, s[52:55], s68 offen offset:0 sc1
    buffer_load_dword v25, v5, s[52:55], s68 offen offset:256 sc1
    buffer_load_dword v26, v5, s[52:55], s68 offen offset:512 sc1
    buffer_load_dword v27, v5, s[52:55], s68 offen offset:768 sc1
    buffer_load_dword v28, v5, s[52:55], s68 offen offset:1024 sc1
    buffer_load_dword v29, v5, s[52:55], s68 offen offset:1280 sc1
    buffer_load_dword v30, v5, s[52:55], s68 offen offset:1536 sc1
    buffer_load_dword v31, v5, s[52:55], s68 offen offset:1792 sc1
    s_waitcnt lgkmcnt(14)
    s_mov_b32 s4, 0x10001
    v_bfe_u32 v23, s4, v5, 1
.Lp1F:
    s_cmp_lg_u32 s81, 63
    s_waitcnt vmcnt(4)
    v_mfma_f32_16x16x32_bf16 v[32:35], v[40:43], v[24:27], 0
    v_bitop3_b32 v16, v24, v25, s71 bitop3:0x7e
    v_bitop3_b32 v17, v26, v27, s71 bitop3:0x7e
    s_waitcnt vmcnt(0)
    v_mfma_f32_16x16x32_bf16 v[32:35], v[40:43], v[28:31], v[32:35]
    v_bitop3_b32 v18, v28, v29, s71 bitop3:0x7e
    v_bitop3_b32 v19, v30, v31, s71 bitop3:0x7e
    v_or3_b32 v16, v16, v17, v18
    v_bitop3_b32 v16, v16, v19, v23 bitop3:0xa8
    v_cmp_ne_u32 vcc, 0, v16
    s_nop 1
    v_cvt_pk_bf16_f32 v11, v32, v33
    s_cbranch_vccnz .Lre1F
.LrcontF:
    buffer_store_dword v11, v6, s[52:55], s65 offen
    buffer_store_dword v2, v6, s[52:55], s66 offen
    s_cbranch_scc1 .LtopF
    s_branch .Lrecend
.Lre1F:
    s_wqm_b64 exec, vcc
    buffer_load_dword v24, v5, s[52:55], s68 offen offset:0 sc1
    buffer_load_dword v25, v5, s[52:55], s68 offen offset:256 sc1
    buffer_load_dword v26, v5, s[52:55], s68 offen offset:512 sc1
    buffer_load_dword v27, v5, s[52:55], s68 offen offset:768 sc1
    buffer_load_dword v28, v5, s[52:55], s68 offen offset:1024 sc1
    buffer_load_dword v29, v5, s[52:55], s68 offen offset:1280 sc1
    buffer_load_dword v30, v5, s[52:55], s68 offen offset:1536 sc1
    buffer_load_dword v31, v5, s[52:55], s68 offen offset:1792 sc1
    s_mov_b64 exec, -1
    s_sub_u32 s59, s59, 1
    s_cbranch_scc0 .Lp1F
    s_mov_b32 s60, 0
    s_waitcnt vmcnt(0)
    s_cmp_lg_u32 s81, 63
    s_branch .LrcontF
.LplF:
    s_cmp_eq_u32 s60, 0
    s_cbranch_scc1 .LlokF
    s_sub_u32 s60, s60, 1
    s_waitcnt vmcnt(0) lgkmcnt(0)
    ds_read_b128 v[24:27], v8
    ds_read_b128 v[48:51], v7 offset:20480
    ds_read_b128 v[52:55], v7 offset:21504
    ds_read_b128 v[56:59], v7 offset:22528
    ds_read_b128 v[60:63], v7 offset:23552
    ds_read_b128 v[88:91], v7 offset:26624
    ds_read_b128 v[92:95], v7 offset:27648
    ds_read_b128 v[96:99], v7 offset:12288
    ds_read_b128 v[100:103], v7 offset:13312
    ds_read_b128 v[104:107], v7 offset:14336
    ds_read_b128 v[108:111], v7 offset:15360
    ds_read_b128 v[80:83], v7 offset:24576
    ds_read_b128 v[84:87], v7 offset:25600
    ds_read_b128 v[64:67], v7 offset:16384
    ds_read_b128 v[68:71], v7 offset:17408
    v_mov_b64 v[32:33], 0
    v_mov_b64 v[34:35], 0
    v_mov_b64 v[36:37], 0
    v_mov_b64 v[38:39], 0
    v_mov_b64 v[40:41], 0
    v_mov_b64 v[42:43], 0
    v_mov_b64 v[44:45], 0
    v_mov_b64 v[46:47], 0
    v_mov_b64 v[72:73], 0
    v_mov_b64 v[74:75], 0
    v_mov_b64 v[76:77], 0
    v_mov_b64 v[78:79], 0
    v_xor_b32 v20, 2048, v8
    v_xor_b32 v21, 4096, v8
    v_xor_b32 v22, 6144, v8
    s_waitcnt lgkmcnt(0)
    s_branch .LokF
.LgiveF:
    s_mov_b32 s60, 0
    s_mov_b32 s59, 0
    s_waitcnt vmcnt(0) lgkmcnt(0)
    s_branch .LcontF
.LkvwF:
    v_lshrrev_b32 v23, 2, v0
    s_mov_b32 s4, s60
.kvw43:
    buffer_load_dword v10, v23, s[52:55], s83 offen sc1
    s_waitcnt vmcnt(0)
    v_cmp_eq_u32 s[72:73], s5, v10
    s_nop 1
    s_bitcmp1_b64 s[72:73], s81
    s_cbranch_scc1 .LkvokF
    s_sub_u32 s4, s4, 1
    s_cbranch_scc0 .kvw43
    s_mov_b32 s60, 0
    s_branch .LkvokF
.LtopS:
    s_bitcmp1_b32 s56, 0
    s_cbranch_scc1 .os44
    s_waitcnt vmcnt(0)
.os44:
    buffer_load_dwordx4 v[24:27], v0, s[52:55], s64 offen offset:0 sc1
    v_cmp_eq_u32 s[72:73], s5, v10
    s_bitcmp1_b64 s[72:73], s81
    s_cbranch_scc0 .LkvwS
.LkvokS:
    v_xor_b32 v20, 2048, v8
    v_xor_b32 v21, 4096, v8
    v_xor_b32 v22, 6144, v8
    s_add_u32 s1, s81, 1
    s_bitcmp1_b64 s[72:73], s1
    s_cselect_b32 s1, s0, 1072693248
    s_add_u32 s1, s1, s69
    v_mov_b64 v[36:37], 0
    v_mov_b64 v[38:39], 0
    v_mov_b64 v[44:45], 0
    v_mov_b64 v[46:47], 0
    v_mov_b64 v[72:73], 0
    v_mov_b64 v[74:75], 0
    v_mov_b64 v[76:77], 0
    v_mov_b64 v[78:79], 0
    s_mov_b32 s59, s60
    s_xor_b32 s71, s71, 1
    s_mov_b64 vcc, -1
.Lp2S:
    s_mov_b64 exec, vcc
    buffer_load_dwordx4 v[24:27], v0, s[52:55], s64 offen offset:0 sc1
    s_mov_b64 exec, -1
    s_sub_u32 s59, s59, 1
    s_cbranch_scc1 .LgiveS
    v_mov_b64 v[40:41], 0
    v_mov_b64 v[42:43], 0
    v_mov_b64 v[32:33], 0
    v_mov_b64 v[34:35], 0
    s_waitcnt vmcnt(1) lgkmcnt(0)
.LokS:
    v_max3_u32 v16, v24, v25, v26
    v_max_u32 v16, v16, v27
    v_smfmac_f32_16x16x64_bf16 v[40:43], v[24:27], v[48:55], v1
    ds_write_b128 v8, v[24:27]
    v_cmp_eq_u32 vcc, -1, v16
    v_smfmac_f32_16x16x64_bf16 v[32:35], v[24:27], v[96:103], v1
    s_cbranch_vccnz .Lp2S
.LcontS:
    s_waitcnt lgkmcnt(0)
    s_barrier
    ds_read_b128 v[48:51], v20 offset:0
    buffer_load_dwordx4 v0, s[52:55], s64 offen offset:1024 sc1 lds
    v_smfmac_f32_16x16x64_bf16 v[44:47], v[24:27], v[56:63], v1
    ds_read_b128 v[56:59], v21 offset:0
    ds_read_b128 v[60:63], v22 offset:0
    v_smfmac_f32_16x16x64_bf16 v[72:75], v[24:27], v[80:87], v1
    v_smfmac_f32_16x16x64_bf16 v[36:39], v[24:27], v[104:111], v1
    v_smfmac_f32_16x16x64_bf16 v[76:79], v[24:27], v[88:95], v1
    ds_read_b128 v[96:99], v7 offset:18432
    ds_read_b128 v[100:103], v7 offset:19456
    s_waitcnt lgkmcnt(4)
    v_smfmac_f32_16x16x64_bf16 v[32:35], v[48:51], v[64:71], v1
    s_mov_b64 vcc, s[76:77]
    v_smfmac_f32_16x16x64_bf16 v[40:43], v[48:51], v[224:231], v1
    buffer_load_dwordx4 v[108:111], v0, s[52:55], s61 offen offset:0 sc1
    v_smfmac_f32_16x16x64_bf16 v[44:47], v[48:51], v[232:239], v1
    s_waitcnt lgkmcnt(3)
    v_smfmac_f32_16x16x64_bf16 v[32:35], v[56:59], v[144:151], v1
    v_mov_b64 v[88:89], 0
    v_smfmac_f32_16x16x64_bf16 v[36:39], v[56:59], v[152:159], v1
    buffer_load_dwordx4 v[104:107], v0, s[52:55], s69 offen offset:0 sc1
    s_waitcnt lgkmcnt(0)
    v_smfmac_f32_16x16x64_bf16 v[36:39], v[48:51], v[96:103], v1
    v_mov_b64 v[90:91], 0
    v_smfmac_f32_16x16x64_bf16 v[32:35], v[60:63], v[176:183], v1
    ds_read_b128 v[100:103], v0 offset:13312
    v_smfmac_f32_16x16x64_bf16 v[36:39], v[60:63], v[184:191], v1
    buffer_load_dwordx4 v[80:83], v0, s[52:55], s63 offen offset:0 sc1
    v_smfmac_f32_16x16x64_bf16 v[72:75], v[56:59], a[112:119], v1
    v_mov_b64 v[92:93], 0
    v_smfmac_f32_16x16x64_bf16 v[76:79], v[56:59], a[120:127], v1
    v_mov_b64 v[94:95], 0
    v_smfmac_f32_16x16x64_bf16 v[72:75], v[60:63], a[144:151], v1
    buffer_load_dwordx4 v[84:87], v0, s[52:55], s63 offen offset:1024 sc1
    v_smfmac_f32_16x16x64_bf16 v[76:79], v[60:63], a[152:159], v1
    v_smfmac_f32_16x16x64_bf16 v[40:43], v[56:59], a[0:7], v1
    s_waitcnt vmcnt(4)
    s_barrier
    ds_read_b128 v[28:31], v8 offset:1024
    v_smfmac_f32_16x16x64_bf16 v[44:47], v[56:59], a[8:15], v1
    ds_read_b128 v[52:55], v20 offset:1024
    ds_read_b128 v[64:67], v21 offset:1024
    v_smfmac_f32_16x16x64_bf16 v[40:43], v[60:63], a[32:39], v1
    buffer_load_dword v10, v3, s[52:55], s1 offen sc1
    ds_read_b128 v[68:71], v22 offset:1024
    v_smfmac_f32_16x16x64_bf16 v[44:47], v[60:63], a[40:47], v1
    buffer_store_dword v11, v6, s[52:55], s80 offen sc1
    v_smfmac_f32_16x16x64_bf16 v[72:75], v[48:51], a[80:87], v1
    v_smfmac_f32_16x16x64_bf16 v[76:79], v[48:51], a[88:95], v1
    s_waitcnt lgkmcnt(2)
    v_smfmac_f32_16x16x64_bf16 v[32:35], v[28:31], v[112:119], v1
    v_smfmac_f32_16x16x64_bf16 v[32:35], v[52:55], v[128:135], v1
    s_waitcnt lgkmcnt(0)
    v_smfmac_f32_16x16x64_bf16 v[32:35], v[64:67], v[160:167], v1
    s_waitcnt vmcnt(5)
    v_swap_b32 v108, v110
    v_smfmac_f32_16x16x64_bf16 v[32:35], v[68:71], v[192:199], v1
    v_swap_b32 v109, v111
    v_smfmac_f32_16x16x64_bf16 v[36:39], v[28:31], v[120:127], v1
    v_smfmac_f32_16x16x64_bf16 v[36:39], v[52:55], v[136:143], v1
    ds_read_b128 v[56:59], v7 offset:4096
    v_add_f32 v32, v32, v34
    v_smfmac_f32_16x16x64_bf16 v[36:39], v[64:67], v[168:175], v1
    ds_read_b128 v[60:63], v7 offset:5120
    v_add_f32 v33, v33, v35
    v_smfmac_f32_16x16x64_bf16 v[36:39], v[68:71], v[200:207], v1
    ds_read_b128 v[48:51], v7 offset:2048
    v_cmp_u_f32 s[6:7], v32, v33
    v_smfmac_f32_16x16x64_bf16 v[40:43], v[28:31], v[208:215], v1
    ds_read_b128 v[24:27], v7 offset:8192
    v_cvt_pk_bf16_f32 v32, v32, v33
    v_smfmac_f32_16x16x64_bf16 v[40:43], v[52:55], v[240:247], v1
    v_add_f32 v36, v36, v38
    v_smfmac_f32_16x16x64_bf16 v[40:43], v[64:67], a[16:23], v1
    v_add_f32 v37, v37, v39
    v_smfmac_f32_16x16x64_bf16 v[40:43], v[68:71], a[48:55], v1
    v_cvt_pk_bf16_f32 v33, v36, v37
    v_smfmac_f32_16x16x64_bf16 v[44:47], v[28:31], v[216:223], v1
    buffer_load_dword v10, v5, s[52:55], s83 offen sc1
    v_mfma_f32_16x16x16_bf16 v[96:99], v[32:33], v[100:101], 0
    v_add_f32 v40, v40, v42
    v_add_f32 v41, v41, v43
    v_smfmac_f32_16x16x64_bf16 v[44:47], v[52:55], v[248:255], v1
    ds_read_b128 v[32:35], v7 offset:10240
    v_cvt_pk_bf16_f32 v40, v40, v41
    v_smfmac_f32_16x16x64_bf16 v[44:47], v[64:67], a[24:31], v1
    v_cvt_pk_bf16_f32 v96, v96, v97
    v_smfmac_f32_16x16x64_bf16 v[44:47], v[68:71], a[56:63], v1
    v_cvt_pk_bf16_f32 v97, v98, v99
    v_smfmac_f32_16x16x64_bf16 v[72:75], v[28:31], a[64:71], v1
    v_mov_b32_dpp v98, v96 row_ror:8 row_mask:0xf bank_mask:0xf
    v_mov_b32_dpp v99, v97 row_ror:8 row_mask:0xf bank_mask:0xf
    v_add_f32 v44, v44, v46
    v_add_f32 v45, v45, v47
    v_cvt_pk_bf16_f32 v41, v44, v45
    s_waitcnt vmcnt(5)
    v_mfma_f32_16x16x32_bf16 v[16:19], v[104:107], v[96:99], 0
    v_mfma_f32_16x16x16_bf16 v[44:47], v[40:41], v[102:103], 0
    v_mfma_f32_16x16x32_bf16 v[36:39], v[108:111], v[96:99], 0
    v_smfmac_f32_16x16x64_bf16 v[72:75], v[52:55], a[96:103], v1
    v_cvt_pk_bf16_f32 v44, v44, v45
    v_cvt_pk_bf16_f32 v45, v46, v47
    v_cndmask_b32 v16, v16, v36, vcc
    v_cndmask_b32 v17, v17, v37, vcc
    v_mfma_f32_16x16x16_bf16 v[40:43], v[44:45], v[96:97], 0
    v_cndmask_b32 v18, v18, v38, vcc
    v_cndmask_b32 v19, v19, v39, vcc
    v_smfmac_f32_16x16x64_bf16 v[72:75], v[64:67], a[128:135], v1
    ds_write_b128 v8, v[16:19] offset:16384
    s_nop 2
    v_cndmask_b32 v40, v40, v42, vcc
    v_cndmask_b32 v41, v41, v43, vcc
    ds_write_b64 v8, v[40:41] offset:17408
    v_smfmac_f32_16x16x64_bf16 v[72:75], v[68:71], a[160:167], v1
    s_cmp_lg_u64 s[6:7], 0
    s_cbranch_scc1 .LplS
.LlokS:
    s_waitcnt lgkmcnt(1)
    s_barrier
    ds_read_b128 v[104:107], v20 offset:16384
    v_smfmac_f32_16x16x64_bf16 v[76:79], v[28:31], a[72:79], v1
    ds_read_b128 v[108:111], v21 offset:16384
    ds_read_b128 v[36:39], v22 offset:16384
    v_smfmac_f32_16x16x64_bf16 v[76:79], v[52:55], a[104:111], v1
    s_waitcnt lgkmcnt(3)
    s_barrier
    ds_read_b64 v[96:97], v20 offset:17408
    v_add_f32 v72, v72, v74
    v_smfmac_f32_16x16x64_bf16 v[76:79], v[64:67], a[136:143], v1
    ds_read_b64 v[98:99], v21 offset:17408
    v_add_f32 v73, v73, v75
    v_smfmac_f32_16x16x64_bf16 v[76:79], v[68:71], a[168:175], v1
    ds_read_b64 v[100:101], v22 offset:17408
    v_cvt_pk_bf16_f32 v72, v72, v73
    s_waitcnt lgkmcnt(5)
    v_add_f32 v16, v16, v104
    v_add_f32 v17, v17, v105
    v_add_f32 v18, v18, v106
    v_add_f32 v19, v19, v107
    s_waitcnt lgkmcnt(3)
    v_pk_add_f32 v[108:109], v[108:109], v[36:37]
    v_pk_add_f32 v[110:111], v[110:111], v[38:39]
    v_pk_add_f32 v[16:17], v[16:17], v[108:109]
    v_pk_add_f32 v[18:19], v[18:19], v[110:111]
    v_max3_f32 v23, v16, v17, v18
    v_max_f32 v23, v23, v19
    s_waitcnt lgkmcnt(0)
    v_pk_add_f32 v[40:41], v[40:41], v[96:97]
    v_pk_add_f32 v[98:99], v[98:99], v[100:101]
    v_pk_add_f32 v[40:41], v[40:41], v[98:99]
    v_max_f32_dpp v23, v23, v23 row_ror:8 row_mask:0xf bank_mask:0xf
    v_add_f32 v76, v76, v78
    v_add_f32_dpp v40, v40, v40 row_ror:8 row_mask:0xf bank_mask:0xf
    v_add_f32_dpp v41, v41, v41 row_ror:8 row_mask:0xf bank_mask:0xf
    v_max3_f32 v20, v40, v41, v23
    v_max3_f32 v21, v40, v41, v23
    v_add_f32 v77, v77, v79
    v_cvt_pk_bf16_f32 v73, v76, v77
    v_permlane16_swap_b32 v20, v21
    v_max_f32 v21, v20, v21
    v_max_f32 v20, v20, v21
    v_mov_b64 v[74:75], 0
    ds_read_b128 v[36:39], v7 offset:11264
    v_permlane32_swap_b32 v21, v20
    v_max_f32 v20, v20, v21
    v_mul_f32 v20, s78, v20
    v_pk_fma_f32 v[40:41], v[40:41], s[78:79], v[20:21] op_sel_hi:[1,0,0] neg_lo:[0,0,1] neg_hi:[0,0,1]
    v_exp_f32 v40, v40
    v_exp_f32 v41, v41
    v_pk_fma_f32 v[16:17], v[16:17], s[78:79], v[20:21] op_sel_hi:[1,0,0] neg_lo:[0,0,1] neg_hi:[0,0,1]
    v_pk_fma_f32 v[18:19], v[18:19], s[78:79], v[20:21] op_sel_hi:[1,0,0] neg_lo:[0,0,1] neg_hi:[0,0,1]
    v_cvt_pk_bf16_f32 v40, v40, v41
    v_exp_f32 v16, v16
    v_exp_f32 v17, v17
    v_mov_b32_dpp v74, v40 quad_perm:[0,1,2,3] row_mask:0xf bank_mask:0x3
    v_mov_b32_dpp v75, v40 quad_perm:[0,1,2,3] row_mask:0xf bank_mask:0xc
    v_cvt_pk_bf16_f32 v76, v16, v17
    v_exp_f32 v18, v18
    v_exp_f32 v19, v19
    v_mov_b32_dpp v78, v76 row_ror:8 row_mask:0xf bank_mask:0xf
    v_cvt_pk_bf16_f32 v77, v18, v19
    v_mfma_f32_16x16x16_bf16 v[96:99], v[72:73], v[74:75], 0
    s_nop 0
    v_mov_b32_dpp v79, v77 row_ror:8 row_mask:0xf bank_mask:0xf
    v_bitop3_b32 v21, v9, -9, s74 bitop3:0x6a
    v_mfma_f32_16x16x32_bf16 v[100:103], v[12:15], v[74:77], 0
    s_waitcnt vmcnt(3)
    v_bitop3_b32 v22, v9, -9, s75 bitop3:0x6a
    v_bitop3_b32 v23, v9, -9, s79 bitop3:0x6a
    v_mfma_f32_16x16x32_bf16 v[104:107], v[80:83], v[76:79], v[96:99]
    ds_read_b128 v[80:83], v0 offset:15360
    ds_read_b128 v[40:43], v7 offset:0
    v_mfma_f32_16x16x32_bf16 v[108:111], v[84:87], v[76:79], v[96:99]
    ds_read_b128 v[84:87], v0 offset:15360
    v_add_f32_dpp v20, v100, v100 row_ror:8 row_mask:0xf bank_mask:0xf
    v_rcp_f32 v20, v20
    s_nop 0
    v_cndmask_b32 v102, 0, v20, vcc
    v_sub_f32 v100, v20, v102
    v_pk_mul_f32 v[104:105], v[104:105], v[100:101] op_sel_hi:[1,0]
    v_pk_mul_f32 v[106:107], v[106:107], v[100:101] op_sel_hi:[1,0]
    v_pk_fma_f32 v[104:105], v[108:109], v[102:103], v[104:105] op_sel_hi:[1,0,1]
    v_pk_fma_f32 v[106:107], v[110:111], v[102:103], v[106:107] op_sel_hi:[1,0,1]
    v_cvt_pk_bf16_f32 v16, v104, v105
    v_cvt_pk_bf16_f32 v17, v106, v107
    ds_write_b64 v9, v[16:17]
    v_mov_b32_dpp v18, v16 row_ror:8 row_mask:0xf bank_mask:0xf
    v_mov_b32_dpp v19, v17 row_ror:8 row_mask:0xf bank_mask:0xf
    s_nop 1
    v_smfmac_f32_16x16x64_bf16 v[88:91], v[16:19], a[176:183], v1 abid:1
    v_smfmac_f32_16x16x64_bf16 v[92:95], v[16:19], a[184:191], v1 abid:1
    s_waitcnt lgkmcnt(0)
    s_barrier
    ds_read_b128 v[96:99], v21 offset:0
    ds_read_b128 v[104:107], v22 offset:0
    ds_read_b128 v[108:111], v23 offset:0
    v_smfmac_f32_16x16x64_bf16 v[80:83], v[16:19], a[192:199], v1 abid:1
    v_smfmac_f32_16x16x64_bf16 v[84:87], v[16:19], a[200:207], v1 abid:1
    s_waitcnt lgkmcnt(2)
    v_smfmac_f32_16x16x64_bf16 v[88:91], v[96:99], a[208:215], v1 abid:1
    ds_read_b128 v[44:47], v7 offset:1024
    v_smfmac_f32_16x16x64_bf16 v[92:95], v[96:99], a[216:223], v1 abid:1
    s_waitcnt lgkmcnt(2)
    ds_read_b128 v[28:31], v7 offset:9216
    v_smfmac_f32_16x16x64_bf16 v[88:91], v[104:107], a[224:231], v1 abid:1
    ds_read_b128 v[52:55], v7 offset:3072
    v_smfmac_f32_16x16x64_bf16 v[92:95], v[104:107], a[232:239], v1 abid:1
    s_waitcnt lgkmcnt(3)
    ds_read_b128 v[64:67], v7 offset:6144
    v_smfmac_f32_16x16x64_bf16 v[88:91], v[108:111], a[240:247], v1 abid:1
    ds_read_b128 v[68:71], v7 offset:7168
    v_smfmac_f32_16x16x64_bf16 v[92:95], v[108:111], a[248:255], v1 abid:1
    s_waitcnt lgkmcnt(4)
    v_smfmac_f32_16x16x64_bf16 v[80:83], v[96:99], v[40:47], v1 abid:1
    s_nop 3
    v_cvt_pk_bf16_f32 v88, v88, v92
    v_cvt_pk_bf16_f32 v89, v89, v93
    v_bfi_b32 v88, 1, s71, v88
    v_cvt_pk_bf16_f32 v90, v90, v94
    v_cvt_pk_bf16_f32 v91, v91, v95
    buffer_store_dwordx4 v[88:91], v4, s[52:55], s67 offen offset:0 sc1
    v_smfmac_f32_16x16x64_bf16 v[80:83], v[104:107], v[56:63], v1 abid:1
    s_waitcnt lgkmcnt(0)
    v_smfmac_f32_16x16x64_bf16 v[80:83], v[108:111], v[24:31], v1 abid:1
    ds_read_b128 v[40:43], v0 offset:14336
    v_smfmac_f32_16x16x64_bf16 v[84:87], v[96:99], v[48:55], v1 abid:1
    v_smfmac_f32_16x16x64_bf16 v[84:87], v[104:107], v[64:71], v1 abid:1
    v_smfmac_f32_16x16x64_bf16 v[84:87], v[108:111], v[32:39], v1 abid:1
    s_nop 7
    v_cvt_pk_bf16_f32 v80, v80, v84
    v_cvt_pk_bf16_f32 v81, v81, v85
    v_bfi_b32 v80, 1, s71, v80
    v_cvt_pk_bf16_f32 v82, v82, v86
    v_cvt_pk_bf16_f32 v83, v83, v87
    buffer_store_dwordx4 v[80:83], v4, s[52:55], s67 offen offset:2048 sc1
    ds_read_b128 v[48:51], v7 offset:20480
    ds_read_b128 v[52:55], v7 offset:21504
    ds_read_b128 v[56:59], v7 offset:22528
    ds_read_b128 v[60:63], v7 offset:23552
    ds_read_b128 v[88:91], v7 offset:26624
    ds_read_b128 v[92:95], v7 offset:27648
    ds_read_b128 v[96:99], v7 offset:12288
    ds_read_b128 v[100:103], v7 offset:13312
    ds_read_b128 v[104:107], v7 offset:14336
    ds_read_b128 v[108:111], v7 offset:15360
    ds_read_b128 v[80:83], v7 offset:24576
    ds_read_b128 v[84:87], v7 offset:25600
    ds_read_b128 v[64:67], v7 offset:16384
    ds_read_b128 v[68:71], v7 offset:17408
    s_mov_b32 s66, s65
    s_add_u32 s62, s62, s2
    s_and_b32 s62, s62, 0x6000
    s_add_u32 s65, s84, s62
    s_add_u32 s64, s85, s62
    s_add_u32 s70, s70, s2
    s_mov_b32 s80, s70
    s_mov_b32 s59, s60
    s_add_u32 s81, s81, 1
    s_add_u32 s69, s69, s3
    s_add_u32 s61, s61, s3
    s_add_u32 s63, s63, s3
    s_bitcmp1_b32 s56, 0
    s_cbranch_scc0 .os45
    s_waitcnt vmcnt(0)
.os45:
    s_waitcnt vmcnt(1)
    buffer_load_dword v24, v5, s[52:55], s68 offen offset:0 sc1
    buffer_load_dword v25, v5, s[52:55], s68 offen offset:256 sc1
    buffer_load_dword v26, v5, s[52:55], s68 offen offset:512 sc1
    buffer_load_dword v27, v5, s[52:55], s68 offen offset:768 sc1
    buffer_load_dword v28, v5, s[52:55], s68 offen offset:1024 sc1
    buffer_load_dword v29, v5, s[52:55], s68 offen offset:1280 sc1
    buffer_load_dword v30, v5, s[52:55], s68 offen offset:1536 sc1
    buffer_load_dword v31, v5, s[52:55], s68 offen offset:1792 sc1
    s_waitcnt lgkmcnt(14)
    s_mov_b32 s4, 0x10001
    v_bfe_u32 v23, s4, v5, 1
.Lp1S:
    s_cmp_lg_u32 s81, 63
    s_waitcnt vmcnt(4)
    v_mfma_f32_16x16x32_bf16 v[32:35], v[40:43], v[24:27], 0
    v_bitop3_b32 v16, v24, v25, s71 bitop3:0x7e
    v_bitop3_b32 v17, v26, v27, s71 bitop3:0x7e
    s_waitcnt vmcnt(0)
    v_mfma_f32_16x16x32_bf16 v[32:35], v[40:43], v[28:31], v[32:35]
    v_bitop3_b32 v18, v28, v29, s71 bitop3:0x7e
    v_bitop3_b32 v19, v30, v31, s71 bitop3:0x7e
    v_or3_b32 v16, v16, v17, v18
    v_bitop3_b32 v16, v16, v19, v23 bitop3:0xa8
    v_cmp_ne_u32 vcc, 0, v16
    s_nop 1
    v_cvt_pk_bf16_f32 v11, v32, v33
    s_cbranch_vccnz .Lre1S
.LrcontS:
    buffer_store_dword v11, v6, s[52:55], s65 offen sc1
    buffer_store_dword v2, v6, s[52:55], s66 offen sc1
    s_cbranch_scc1 .LtopS
    s_branch .Lrecend
.Lre1S:
    s_wqm_b64 exec, vcc
    buffer_load_dword v24, v5, s[52:55], s68 offen offset:0 sc1
    buffer_load_dword v25, v5, s[52:55], s68 offen offset:256 sc1
    buffer_load_dword v26, v5, s[52:55], s68 offen offset:512 sc1
    buffer_load_dword v27, v5, s[52:55], s68 offen offset:768 sc1
    buffer_load_dword v28, v5, s[52:55], s68 offen offset:1024 sc1
    buffer_load_dword v29, v5, s[52:55], s68 offen offset:1280 sc1
    buffer_load_dword v30, v5, s[52:55], s68 offen offset:1536 sc1
    buffer_load_dword v31, v5, s[52:55], s68 offen offset:1792 sc1
    s_mov_b64 exec, -1
    s_sub_u32 s59, s59, 1
    s_cbranch_scc0 .Lp1S
    s_mov_b32 s60, 0
    s_waitcnt vmcnt(0)
    s_cmp_lg_u32 s81, 63
    s_branch .LrcontS
.LplS:
    s_cmp_eq_u32 s60, 0
    s_cbranch_scc1 .LlokS
    s_sub_u32 s60, s60, 1
    s_waitcnt vmcnt(0) lgkmcnt(0)
    ds_read_b128 v[24:27], v8
    ds_read_b128 v[48:51], v7 offset:20480
    ds_read_b128 v[52:55], v7 offset:21504
    ds_read_b128 v[56:59], v7 offset:22528
    ds_read_b128 v[60:63], v7 offset:23552
    ds_read_b128 v[88:91], v7 offset:26624
    ds_read_b128 v[92:95], v7 offset:27648
    ds_read_b128 v[96:99], v7 offset:12288
    ds_read_b128 v[100:103], v7 offset:13312
    ds_read_b128 v[104:107], v7 offset:14336
    ds_read_b128 v[108:111], v7 offset:15360
    ds_read_b128 v[80:83], v7 offset:24576
    ds_read_b128 v[84:87], v7 offset:25600
    ds_read_b128 v[64:67], v7 offset:16384
    ds_read_b128 v[68:71], v7 offset:17408
    v_mov_b64 v[32:33], 0
    v_mov_b64 v[34:35], 0
    v_mov_b64 v[36:37], 0
    v_mov_b64 v[38:39], 0
    v_mov_b64 v[40:41], 0
    v_mov_b64 v[42:43], 0
    v_mov_b64 v[44:45], 0
    v_mov_b64 v[46:47], 0
    v_mov_b64 v[72:73], 0
    v_mov_b64 v[74:75], 0
    v_mov_b64 v[76:77], 0
    v_mov_b64 v[78:79], 0
    v_xor_b32 v20, 2048, v8
    v_xor_b32 v21, 4096, v8
    v_xor_b32 v22, 6144, v8
    s_waitcnt lgkmcnt(0)
    s_branch .LokS
.LgiveS:
    s_mov_b32 s60, 0
    s_mov_b32 s59, 0
    s_waitcnt vmcnt(0) lgkmcnt(0)
    s_branch .LcontS
.LkvwS:
    v_lshrrev_b32 v23, 2, v0
    s_mov_b32 s4, s60
.kvw46:
    buffer_load_dword v10, v23, s[52:55], s83 offen sc1
    s_waitcnt vmcnt(0)
    v_cmp_eq_u32 s[72:73], s5, v10
    s_nop 1
    s_bitcmp1_b64 s[72:73], s81
    s_cbranch_scc1 .LkvokS
    s_sub_u32 s4, s4, 1
    s_cbranch_scc0 .kvw46
    s_mov_b32 s60, 0
    s_branch .LkvokS
.Lrecend:
    buffer_store_dword v11, v6, s[52:55], s70 offen sc1
    s_branch .Lend
.Lend:
    s_endpgm

.section .rodata,"a"
.p2align 6
.amdhsa_kernel parallel_sum__memory_aug_recurrent_mem_tr__swiglu_ffn__prompt_kernel
  .amdhsa_next_free_vgpr 512
  .amdhsa_next_free_sgpr 102
  .amdhsa_accum_offset 256
  .amdhsa_group_segment_fixed_size 0
  .amdhsa_kernarg_size 112
  .amdhsa_user_sgpr_count 2
  .amdhsa_user_sgpr_kernarg_segment_ptr 1
  .amdhsa_system_sgpr_workgroup_id_x 1
.end_amdhsa_kernel
```
